```python
import torch

def _softmax(x, axis=-1):
    return torch.softmax(x, dim=axis)
def _gelu(x):
    return torch.nn.functional.gelu(x, approximate="tanh")
def _silu(x):
    return torch.nn.functional.silu(x)
def _sigmoid(x):
    return torch.sigmoid(x)
def _layernorm(x, axis=-1, eps=1e-5):
    m = x.mean(dim=axis, keepdim=True)
    v = x.var(dim=axis, keepdim=True, unbiased=False)
    return (x - m) / torch.sqrt(v + eps)
def _scatter_add(tgt, idx, src, axis=0):
    return tgt.clone().index_add_(axis, idx, src)
def _segment_sum(src, seg, n):
    out = torch.zeros((n,) + src.shape[1:], dtype=src.dtype)
    return out.index_add_(0, seg, src)
def _pad(x, pw):
    flat = tuple(v for pair in reversed(pw) for v in pair)
    return torch.nn.functional.pad(x, flat)

kernel_name = 'concat_heads__ssm_conv_h3__sliding_local_dilated__prompt'

def setup_inputs():

    _w = (lambda a: (lambda t: t.to(torch.bfloat16) if t.is_floating_point() else t)(torch.as_tensor(a)))
    def _A_setup():
        B, S, D = 1, 2048, 640
        ks = 4
        return {
            "q": _w((lambda *s: torch.randn(*s, dtype=torch.bfloat16) * 0.05)(B, S, D)),
            "k": _w((lambda *s: torch.randn(*s, dtype=torch.bfloat16) * 0.8)(B, S, D)),
            "v": _w((lambda *s: torch.randn(*s, dtype=torch.bfloat16) * 0.8)(B, S, D)),
            "shift_k": _w((lambda *s: torch.randn(*s, dtype=torch.bfloat16) * 0.8)(D, ks) * 0.5),
            "ssm_k": _w((lambda *s: torch.randn(*s, dtype=torch.bfloat16) * 3.2)(D, S) * (1.0 / S ** 0.5)),
            "ssm_D": _w((lambda *s: torch.randn(*s, dtype=torch.bfloat16) * 0.8)(D)),
        }
    _A_in = _A_setup()

    def _B_setup():
        B, S, D = 1, 2048, 640
        return {
            "x": _w((lambda *s: torch.randn(*s, dtype=torch.bfloat16) * 0.2)(B, S, D)),
            "wqkv": _w((lambda *s: torch.randn(*s, dtype=torch.bfloat16) * 0.2)(D, 3 * D)),
            "wo": _w((lambda *s: torch.randn(*s, dtype=torch.bfloat16) * 0.05)(D, D)),
        }
    _B_in = _B_setup()

    return {
        "A_q": _A_in["q"],
        "A_k": _A_in["k"],
        "A_v": _A_in["v"],
        "A_shift_k": _A_in["shift_k"],
        "A_ssm_k": _A_in["ssm_k"],
        "A_ssm_D": _A_in["ssm_D"],
        "B_x": _B_in["x"],
        "B_wqkv": _B_in["wqkv"],
        "B_wo": _B_in["wo"],
    }

def reference(A_q, A_k, A_v, A_shift_k, A_ssm_k, A_ssm_D, B_x, B_wqkv, B_wo):
    def _A_ref(q, k, v, shift_k, ssm_k, ssm_D):
        B, S, D = q.shape
        ks = shift_k.shape[-1]
        k_pad = _pad(k, ((0, 0), (ks - 1, 0), (0, 0)))
        k_shift = torch.zeros_like(k)
        for t in range(ks):
            k_shift = k_shift + k_pad[:, t:t + S, :] * shift_k[:, ks - 1 - t][None, None, :]
        kv = k_shift * v
        L = 2 * S
        kv_pad = _pad(kv, ((0, 0), (0, S), (0, 0)))
        kf_pad = _pad(ssm_k, ((0, 0), (0, S)))
        kv_f = (lambda x, axes=(-2,-1): torch.fft.rfft2(x.float(), dim=axes))(kv_pad[:, None, :, :], axes=(1, 2))
        kf_f = (lambda x, axes=(-2,-1): torch.fft.rfft2(x.float(), dim=axes))(kf_pad[:, None, :], axes=(1, 2))
        kf_f = (lambda x, *d: x.permute(*d))(kf_f, 1, 2, 0)
        y_f = kv_f * kf_f[None, :, :, :]
        y = (lambda x, s, axes=(-2,-1): torch.fft.irfft2(x, s=s, dim=axes).to(torch.bfloat16))(y_f, (1, L), axes=(1, 2))[:, 0, :S, :]
        y = y + kv * ssm_D[None, None, :]
        return q * y

    def _B_ref(x, wqkv, wo):
        B, S, D = x.shape
        H = 32; Dh = D // H
        W, dil = 8, 2
        qkv = (lambda x, *d: x.permute(*d))((x @ wqkv).reshape(B, S, 3, H, Dh), 2, 0, 3, 1, 4)
        q, k, v = qkv[0], qkv[1], qkv[2]
        scale = Dh ** -0.5
        pos = torch.arange(S)
        off = torch.arange(W) * dil
        idx = pos[:, None] - off[None, :]
        mask = idx >= 0
        idx_c = torch.where(mask, idx, 0).reshape(-1)
        kg = k[:, :, idx_c, :].reshape(B, H, S, W, Dh)
        vg = v[:, :, idx_c, :].reshape(B, H, S, W, Dh)
        logits = torch.einsum("bhsd,bhswd->bhsw", q, kg) * scale
        logits = torch.where(mask[None, None, :, :], logits, -1e9)
        attn = _softmax(logits, axis=-1)
        o = torch.einsum("bhsw,bhswd->bhsd", attn, vg)
        return (lambda x, *d: x.permute(*d))(o, 0, 2, 1, 3).reshape(B, S, D) @ wo

    a = _A_ref(A_q, A_k, A_v, A_shift_k, A_ssm_k, A_ssm_D)
    b = _B_ref(B_x, B_wqkv, B_wo)
    return torch.concatenate([a, b], axis=-1)
```

```asm
; @launch kernel=mega_kernel grid=(256,1,1) block=(512,1,1) lds=163840
.amdgcn_target "amdgcn-amd-amdhsa--gfx950"
.text
.globl mega_kernel
.p2align 8
.type mega_kernel,@function
mega_kernel:
  s_cmp_ge_u32 s2, 256
  s_cbranch_scc1 L_exit
  s_load_dwordx2 s[48:49], s[0:1], 88
  s_load_dwordx4 s[40:43], s[0:1], 48
  s_load_dwordx4 s[44:47], s[0:1], 8
  s_load_dwordx2 s[62:63], s[0:1], 64
  v_and_b32 v1, 63, v0
  v_lshrrev_b32 v2, 6, v0
  s_mov_b32 s99, 300000
  v_readfirstlane_b32 s33, v2
  s_cmp_ge_u32 s2, 176
  s_cbranch_scc1 L_A
  s_cmp_eq_u32 s33, 4
  s_cbranch_scc1 L_ld0
  s_cmp_eq_u32 s33, 5
  s_cbranch_scc1 L_ld1
  s_cmp_ge_u32 s33, 6
  s_cbranch_scc1 L_idle
  v_and_b32 v220, 15, v1
  v_lshrrev_b32 v221, 4, v1
  v_mul_u32_u24 v222, 208, v220
  s_lshl_b32 s22, s33, 2
  s_add_u32 s22, s22, 0
  s_mul_i32 s23, s22, 52
  s_lshr_b32 s23, s23, 8
  s_mul_i32 s24, s23, 5
  s_sub_u32 s22, s22, s24
  s_lshl_b32 s22, s22, 4
  s_mul_i32 s23, s23, 23296
  v_lshl_add_u32 v223, v221, 2, s22
  v_mul_u32_u24 v224, 13, v223
  v_lshrrev_b32 v224, 8, v224
  v_lshlrev_b32 v224, 3, v224
  v_lshl_add_u32 v224, v223, 1, v224
  v_add3_u32 v248, v224, v222, s23
  s_lshl_b32 s22, s33, 2
  s_add_u32 s22, s22, 1
  s_mul_i32 s23, s22, 52
  s_lshr_b32 s23, s23, 8
  s_mul_i32 s24, s23, 5
  s_sub_u32 s22, s22, s24
  s_lshl_b32 s22, s22, 4
  s_mul_i32 s23, s23, 23296
  v_lshl_add_u32 v223, v221, 2, s22
  v_mul_u32_u24 v224, 13, v223
  v_lshrrev_b32 v224, 8, v224
  v_lshlrev_b32 v224, 3, v224
  v_lshl_add_u32 v224, v223, 1, v224
  v_add3_u32 v249, v224, v222, s23
  s_lshl_b32 s22, s33, 2
  s_add_u32 s22, s22, 2
  s_mul_i32 s23, s22, 52
  s_lshr_b32 s23, s23, 8
  s_mul_i32 s24, s23, 5
  s_sub_u32 s22, s22, s24
  s_lshl_b32 s22, s22, 4
  s_mul_i32 s23, s23, 23296
  v_lshl_add_u32 v223, v221, 2, s22
  v_mul_u32_u24 v224, 13, v223
  v_lshrrev_b32 v224, 8, v224
  v_lshlrev_b32 v224, 3, v224
  v_lshl_add_u32 v224, v223, 1, v224
  v_add3_u32 v250, v224, v222, s23
  s_lshl_b32 s22, s33, 2
  s_add_u32 s22, s22, 3
  s_mul_i32 s23, s22, 52
  s_lshr_b32 s23, s23, 8
  s_mul_i32 s24, s23, 5
  s_sub_u32 s22, s22, s24
  s_lshl_b32 s22, s22, 4
  s_mul_i32 s23, s23, 23296
  v_lshl_add_u32 v223, v221, 2, s22
  v_mul_u32_u24 v224, 13, v223
  v_lshrrev_b32 v224, 8, v224
  v_lshlrev_b32 v224, 3, v224
  v_lshl_add_u32 v224, v223, 1, v224
  v_add3_u32 v251, v224, v222, s23
  s_and_b32 s24, s33, 3
  s_lshr_b32 s25, s33, 2
  v_and_b32 v227, 15, v1
  v_lshrrev_b32 v228, 4, v1
  v_lshlrev_b32 v229, 2, v228
  v_mov_b32 v232, 0xff800000
  v_add_u32 v230, 0, v229
  v_add_u32 v231, 9, v227
  v_cmp_ge_u32 vcc, v230, v231
  s_nop 1
  v_cndmask_b32_e64 v238, v232, 0, vcc
  v_cmp_le_u32 s[22:23], v230, v227
  v_add_u32 v231, 7, v230
  v_cmp_ge_u32 vcc, v231, v227
  s_nop 1
  s_and_b64 vcc, vcc, s[22:23]
  v_cndmask_b32_e64 v242, v232, 0, vcc
  v_add_u32 v230, 1, v229
  v_add_u32 v231, 9, v227
  v_cmp_ge_u32 vcc, v230, v231
  s_nop 1
  v_cndmask_b32_e64 v239, v232, 0, vcc
  v_cmp_le_u32 s[22:23], v230, v227
  v_add_u32 v231, 7, v230
  v_cmp_ge_u32 vcc, v231, v227
  s_nop 1
  s_and_b64 vcc, vcc, s[22:23]
  v_cndmask_b32_e64 v243, v232, 0, vcc
  v_add_u32 v230, 2, v229
  v_add_u32 v231, 9, v227
  v_cmp_ge_u32 vcc, v230, v231
  s_nop 1
  v_cndmask_b32_e64 v240, v232, 0, vcc
  v_cmp_le_u32 s[22:23], v230, v227
  v_add_u32 v231, 7, v230
  v_cmp_ge_u32 vcc, v231, v227
  s_nop 1
  s_and_b64 vcc, vcc, s[22:23]
  v_cndmask_b32_e64 v244, v232, 0, vcc
  v_add_u32 v230, 3, v229
  v_add_u32 v231, 9, v227
  v_cmp_ge_u32 vcc, v230, v231
  s_nop 1
  v_cndmask_b32_e64 v241, v232, 0, vcc
  v_cmp_le_u32 s[22:23], v230, v227
  v_add_u32 v231, 7, v230
  v_cmp_ge_u32 vcc, v231, v227
  s_nop 1
  s_and_b64 vcc, vcc, s[22:23]
  v_cndmask_b32_e64 v245, v232, 0, vcc
  v_cmp_gt_u32 vcc, 3, v228
  s_nop 1
  v_cndmask_b32 v255, 0, -1, vcc
  v_cmp_gt_u32 vcc, 2, v228
  s_nop 1
  v_cndmask_b32 v226, 0, -1, vcc
  s_mul_i32 s30, s24, 48
  v_lshlrev_b32 v229, 1, v227
  s_add_u32 s31, s25, 16
  v_add_u32 v229, s31, v229
  v_mul_u32_u24 v230, 208, v229
  v_lshl_add_u32 v230, v228, 4, v230
  v_add_u32 v246, s30, v230
  v_subrev_u32 v229, 32, v229
  v_max_i32 v229, 0, v229
  v_mul_u32_u24 v230, 208, v229
  v_lshl_add_u32 v230, v228, 4, v230
  v_add_u32 v247, s30, v230
  v_bfe_u32 v229, v1, 2, 2
  v_lshl_add_u32 v229, v228, 2, v229
  v_lshlrev_b32 v229, 1, v229
  v_add_u32 v229, s31, v229
  v_and_b32 v231, 3, v1
  v_lshlrev_b32 v231, 3, v231
  v_add_u32 v231, s30, v231
  v_mul_u32_u24 v230, 208, v229
  v_add_u32 v252, v230, v231
  v_subrev_u32 v229, 32, v229
  v_max_i32 v229, 0, v229
  v_mul_u32_u24 v230, 208, v229
  v_add_u32 v253, v230, v231
  v_lshlrev_b32 v229, 1, v227
  v_add_u32 v229, s25, v229
  v_mul_u32_u24 v229, 160, v229
  s_mul_i32 s30, s24, 40
  v_lshl_add_u32 v229, v228, 3, v229
  v_add_u32 v254, s30, v229
  v_add_u32 v254, 69888, v254
  v_mov_b32 v2, 163584
  v_mov_b32 v3, 1
  v_and_b32 v220, 15, v1
  v_lshrrev_b32 v221, 4, v1
  v_lshrrev_b32 v222, 1, v220
  v_xor_b32 v223, v221, v222
  v_lshlrev_b32 v224, 7, v220
  v_lshl_add_u32 v13, v223, 4, v224
  v_xor_b32 v14, 64, v13
  v_and_b32 v223, 1, v221
  v_lshrrev_b32 v224, 2, v220
  v_lshl_add_u32 v223, v223, 2, v224
  v_lshrrev_b32 v222, 1, v221
  v_lshl_add_u32 v222, v222, 4, v223
  s_lshl_b32 s30, s33, 2
  v_xor_b32 v223, s30, v223
  v_lshlrev_b32 v223, 5, v223
  v_lshl_add_u32 v223, v222, 9, v223
  v_and_b32 v224, 3, v1
  v_lshl_add_u32 v223, v224, 3, v223
  v_add_u32 v15, 14336, v223
  v_mov_b32 v108, 0
  v_mov_b32 v109, 0
  v_mov_b32 v110, 0
  v_mov_b32 v111, 0
  v_mov_b32 v112, 0
  v_mov_b32 v113, 0
  v_mov_b32 v114, 0
  v_mov_b32 v115, 0
  v_mov_b32 v116, 0
  v_mov_b32 v117, 0
  v_mov_b32 v118, 0
  v_mov_b32 v119, 0
  v_mov_b32 v120, 0
  v_mov_b32 v121, 0
  v_mov_b32 v122, 0
  v_mov_b32 v123, 0
  v_mov_b32 v124, 0
  v_mov_b32 v125, 0
  v_mov_b32 v126, 0
  v_mov_b32 v127, 0
  v_mov_b32 v128, 0
  v_mov_b32 v129, 0
  v_mov_b32 v130, 0
  v_mov_b32 v131, 0
  v_mov_b32 v132, 0
  v_mov_b32 v133, 0
  v_mov_b32 v134, 0
  v_mov_b32 v135, 0
  v_mov_b32 v136, 0
  v_mov_b32 v137, 0
  v_mov_b32 v138, 0
  v_mov_b32 v139, 0
  v_mov_b32 v140, 0
  v_mov_b32 v141, 0
  v_mov_b32 v142, 0
  v_mov_b32 v143, 0
  v_mov_b32 v144, 0
  v_mov_b32 v145, 0
  v_mov_b32 v146, 0
  v_mov_b32 v147, 0
  v_mov_b32 v148, 0
  v_mov_b32 v149, 0
  v_mov_b32 v150, 0
  v_mov_b32 v151, 0
  v_mov_b32 v152, 0
  v_mov_b32 v153, 0
  v_mov_b32 v154, 0
  v_mov_b32 v155, 0
  v_mov_b32 v156, 0
  v_mov_b32 v157, 0
  v_mov_b32 v158, 0
  v_mov_b32 v159, 0
  v_mov_b32 v160, 0
  v_mov_b32 v161, 0
  v_mov_b32 v162, 0
  v_mov_b32 v163, 0
  v_mov_b32 v164, 0
  v_mov_b32 v165, 0
  v_mov_b32 v166, 0
  v_mov_b32 v167, 0
  v_mov_b32 v168, 0
  v_mov_b32 v169, 0
  v_mov_b32 v170, 0
  v_mov_b32 v171, 0
  v_mov_b32 v172, 0
  v_mov_b32 v173, 0
  v_mov_b32 v174, 0
  v_mov_b32 v175, 0
  v_mov_b32 v176, 0
  v_mov_b32 v177, 0
  v_mov_b32 v178, 0
  v_mov_b32 v179, 0
  v_mov_b32 v180, 0
  v_mov_b32 v181, 0
  v_mov_b32 v182, 0
  v_mov_b32 v183, 0
  v_mov_b32 v184, 0
  v_mov_b32 v185, 0
  v_mov_b32 v186, 0
  v_mov_b32 v187, 0
  v_mov_b32 v188, 0
  v_mov_b32 v189, 0
  v_mov_b32 v190, 0
  v_mov_b32 v191, 0
  v_mov_b32 v192, 0
  v_mov_b32 v193, 0
  v_mov_b32 v194, 0
  v_mov_b32 v195, 0
  v_mov_b32 v196, 0
  v_mov_b32 v197, 0
  v_mov_b32 v198, 0
  v_mov_b32 v199, 0
  v_mov_b32 v200, 0
  v_mov_b32 v201, 0
  v_mov_b32 v202, 0
  v_mov_b32 v203, 0
  v_mov_b32 v204, 0
  v_mov_b32 v205, 0
  v_mov_b32 v206, 0
  v_mov_b32 v207, 0
  v_mov_b32 v208, 0
  v_mov_b32 v209, 0
  v_mov_b32 v210, 0
  v_mov_b32 v211, 0
  v_mov_b32 v212, 0
  v_mov_b32 v213, 0
  v_mov_b32 v214, 0
  v_mov_b32 v215, 0
  v_mov_b32 v216, 0
  v_mov_b32 v217, 0
  v_mov_b32 v218, 0
  v_mov_b32 v219, 0
  s_barrier
  s_mov_b32 s23, 0
  s_mov_b32 s21, 0
  v_add_u32 v4, s23, v15
  v_add_u32 v16, s23, v13
  v_add_u32 v17, s23, v14
  v_xor_b32 v5, 32, v4
  v_xor_b32 v6, 64, v4
  v_xor_b32 v7, 96, v4
gc_sp1:
  ds_read_b64 v[220:221], v2 offset:0
  s_waitcnt lgkmcnt(0)
  v_readfirstlane_b32 s30, v220
  v_readfirstlane_b32 s31, v221
  s_nop 0
  s_min_u32 s30, s30, s31
  s_cmp_ge_u32 s30, 1
  s_cbranch_scc1 gc_sp1d
  s_sub_u32 s99, s99, 1
  s_cbranch_scc0 gc_sp1
  s_branch L_exit
gc_sp1d:
  s_mov_b32 s24, 47104
  s_mov_b32 s32, 2
  ds_read_b64_tr_b16 v[76:77], v4 offset:0
  ds_read_b64_tr_b16 v[78:79], v4 offset:4096
  ds_read_b64_tr_b16 v[80:81], v5 offset:0
  ds_read_b64_tr_b16 v[82:83], v5 offset:4096
  ds_read_b64_tr_b16 v[84:85], v6 offset:0
  ds_read_b64_tr_b16 v[86:87], v6 offset:4096
  ds_read_b64_tr_b16 v[88:89], v7 offset:0
  ds_read_b64_tr_b16 v[90:91], v7 offset:4096
  ds_read_b128 v[20:23], v16 offset:0
  ds_read_b128 v[24:27], v16 offset:2048
  ds_read_b128 v[28:31], v16 offset:4096
  ds_read_b128 v[32:35], v16 offset:6144
  ds_read_b128 v[36:39], v16 offset:8192
  ds_read_b128 v[40:43], v16 offset:10240
  ds_read_b128 v[44:47], v16 offset:12288
gca_loop:
  s_waitcnt lgkmcnt(0)
  v_mfma_f32_16x16x32_bf16 v[108:111], v[76:79], v[20:23], v[108:111]
  ds_read_b64_tr_b16 v[92:93], v4 offset:16384
  v_mfma_f32_16x16x32_bf16 v[136:139], v[80:83], v[20:23], v[136:139]
  ds_read_b64_tr_b16 v[94:95], v4 offset:20480
  v_mfma_f32_16x16x32_bf16 v[164:167], v[84:87], v[20:23], v[164:167]
  ds_read_b64_tr_b16 v[96:97], v5 offset:16384
  v_mfma_f32_16x16x32_bf16 v[192:195], v[88:91], v[20:23], v[192:195]
  ds_read_b64_tr_b16 v[98:99], v5 offset:20480
  v_mfma_f32_16x16x32_bf16 v[112:115], v[76:79], v[24:27], v[112:115]
  ds_read_b64_tr_b16 v[100:101], v6 offset:16384
  v_mfma_f32_16x16x32_bf16 v[140:143], v[80:83], v[24:27], v[140:143]
  ds_read_b64_tr_b16 v[102:103], v6 offset:20480
  v_mfma_f32_16x16x32_bf16 v[168:171], v[84:87], v[24:27], v[168:171]
  ds_read_b64_tr_b16 v[104:105], v7 offset:16384
  v_mfma_f32_16x16x32_bf16 v[196:199], v[88:91], v[24:27], v[196:199]
  ds_read_b64_tr_b16 v[106:107], v7 offset:20480
  v_mfma_f32_16x16x32_bf16 v[116:119], v[76:79], v[28:31], v[116:119]
  ds_read_b128 v[48:51], v17 offset:0
  v_mfma_f32_16x16x32_bf16 v[144:147], v[80:83], v[28:31], v[144:147]
  ds_read_b128 v[52:55], v17 offset:2048
  v_mfma_f32_16x16x32_bf16 v[172:175], v[84:87], v[28:31], v[172:175]
  ds_read_b128 v[56:59], v17 offset:4096
  v_mfma_f32_16x16x32_bf16 v[200:203], v[88:91], v[28:31], v[200:203]
  ds_read_b128 v[60:63], v17 offset:6144
  v_mfma_f32_16x16x32_bf16 v[120:123], v[76:79], v[32:35], v[120:123]
  ds_read_b128 v[64:67], v17 offset:8192
  v_mfma_f32_16x16x32_bf16 v[148:151], v[80:83], v[32:35], v[148:151]
  ds_read_b128 v[68:71], v17 offset:10240
  v_mfma_f32_16x16x32_bf16 v[176:179], v[84:87], v[32:35], v[176:179]
  ds_read_b128 v[72:75], v17 offset:12288
  v_mfma_f32_16x16x32_bf16 v[204:207], v[88:91], v[32:35], v[204:207]
  v_add_u32 v8, s24, v15
  v_mfma_f32_16x16x32_bf16 v[124:127], v[76:79], v[36:39], v[124:127]
  v_add_u32 v18, s24, v13
  v_mfma_f32_16x16x32_bf16 v[152:155], v[80:83], v[36:39], v[152:155]
  v_xor_b32 v9, 32, v8
  v_mfma_f32_16x16x32_bf16 v[180:183], v[84:87], v[36:39], v[180:183]
  v_xor_b32 v10, 64, v8
  v_mfma_f32_16x16x32_bf16 v[208:211], v[88:91], v[36:39], v[208:211]
  v_xor_b32 v11, 96, v8
  v_mfma_f32_16x16x32_bf16 v[128:131], v[76:79], v[40:43], v[128:131]
  ds_read_b64 v[220:221], v2 offset:0
  v_mfma_f32_16x16x32_bf16 v[156:159], v[80:83], v[40:43], v[156:159]
  v_mfma_f32_16x16x32_bf16 v[184:187], v[84:87], v[40:43], v[184:187]
  v_mfma_f32_16x16x32_bf16 v[212:215], v[88:91], v[40:43], v[212:215]
  v_mfma_f32_16x16x32_bf16 v[132:135], v[76:79], v[44:47], v[132:135]
  v_mfma_f32_16x16x32_bf16 v[160:163], v[80:83], v[44:47], v[160:163]
  v_mfma_f32_16x16x32_bf16 v[188:191], v[84:87], v[44:47], v[188:191]
  v_mfma_f32_16x16x32_bf16 v[216:219], v[88:91], v[44:47], v[216:219]
  s_waitcnt lgkmcnt(0)
  s_mov_b64 exec, 1
  ds_add_u32 v2, v3 offset:8
  s_mov_b64 exec, -1
  s_cmp_eq_u32 s21, 9
  s_cbranch_scc1 gca_last
  v_readfirstlane_b32 s30, v220
  v_readfirstlane_b32 s31, v221
  s_add_u32 s21, s21, 1
  s_min_u32 s30, s30, s31
  s_cmp_ge_u32 s30, s32
  s_cbranch_scc1 gca_rdy
gca_sp2:
  ds_read_b64 v[220:221], v2 offset:0
  s_waitcnt lgkmcnt(0)
  v_readfirstlane_b32 s30, v220
  v_readfirstlane_b32 s31, v221
  s_nop 0
  s_min_u32 s30, s30, s31
  s_cmp_ge_u32 s30, s32
  s_cbranch_scc1 gca_sp2d
  s_sub_u32 s99, s99, 1
  s_cbranch_scc0 gca_sp2
  s_branch L_exit
gca_sp2d:
gca_rdy:
  v_mfma_f32_16x16x32_bf16 v[108:111], v[92:95], v[48:51], v[108:111]
  ds_read_b64_tr_b16 v[76:77], v8 offset:0
  v_mfma_f32_16x16x32_bf16 v[136:139], v[96:99], v[48:51], v[136:139]
  ds_read_b64_tr_b16 v[78:79], v8 offset:4096
  v_mfma_f32_16x16x32_bf16 v[164:167], v[100:103], v[48:51], v[164:167]
  ds_read_b64_tr_b16 v[80:81], v9 offset:0
  v_mfma_f32_16x16x32_bf16 v[192:195], v[104:107], v[48:51], v[192:195]
  ds_read_b64_tr_b16 v[82:83], v9 offset:4096
  v_mfma_f32_16x16x32_bf16 v[112:115], v[92:95], v[52:55], v[112:115]
  ds_read_b64_tr_b16 v[84:85], v10 offset:0
  v_mfma_f32_16x16x32_bf16 v[140:143], v[96:99], v[52:55], v[140:143]
  ds_read_b64_tr_b16 v[86:87], v10 offset:4096
  v_mfma_f32_16x16x32_bf16 v[168:171], v[100:103], v[52:55], v[168:171]
  ds_read_b64_tr_b16 v[88:89], v11 offset:0
  v_mfma_f32_16x16x32_bf16 v[196:199], v[104:107], v[52:55], v[196:199]
  ds_read_b64_tr_b16 v[90:91], v11 offset:4096
  v_mfma_f32_16x16x32_bf16 v[116:119], v[92:95], v[56:59], v[116:119]
  ds_read_b128 v[20:23], v18 offset:0
  v_mfma_f32_16x16x32_bf16 v[144:147], v[96:99], v[56:59], v[144:147]
  ds_read_b128 v[24:27], v18 offset:2048
  v_mfma_f32_16x16x32_bf16 v[172:175], v[100:103], v[56:59], v[172:175]
  ds_read_b128 v[28:31], v18 offset:4096
  v_mfma_f32_16x16x32_bf16 v[200:203], v[104:107], v[56:59], v[200:203]
  ds_read_b128 v[32:35], v18 offset:6144
  v_mfma_f32_16x16x32_bf16 v[120:123], v[92:95], v[60:63], v[120:123]
  ds_read_b128 v[36:39], v18 offset:8192
  v_mfma_f32_16x16x32_bf16 v[148:151], v[96:99], v[60:63], v[148:151]
  ds_read_b128 v[40:43], v18 offset:10240
  v_mfma_f32_16x16x32_bf16 v[176:179], v[100:103], v[60:63], v[176:179]
  ds_read_b128 v[44:47], v18 offset:12288
  v_mfma_f32_16x16x32_bf16 v[204:207], v[104:107], v[60:63], v[204:207]
  v_add_u32 v17, s24, v14
  v_mfma_f32_16x16x32_bf16 v[124:127], v[92:95], v[64:67], v[124:127]
  v_mov_b32 v4, v8
  v_mfma_f32_16x16x32_bf16 v[152:155], v[96:99], v[64:67], v[152:155]
  v_mov_b32 v5, v9
  v_mfma_f32_16x16x32_bf16 v[180:183], v[100:103], v[64:67], v[180:183]
  v_mov_b32 v6, v10
  v_mfma_f32_16x16x32_bf16 v[208:211], v[104:107], v[64:67], v[208:211]
  v_mov_b32 v7, v11
  v_mfma_f32_16x16x32_bf16 v[128:131], v[92:95], v[68:71], v[128:131]
  v_mfma_f32_16x16x32_bf16 v[156:159], v[96:99], v[68:71], v[156:159]
  v_mfma_f32_16x16x32_bf16 v[184:187], v[100:103], v[68:71], v[184:187]
  v_mfma_f32_16x16x32_bf16 v[212:215], v[104:107], v[68:71], v[212:215]
  v_mfma_f32_16x16x32_bf16 v[132:135], v[92:95], v[72:75], v[132:135]
  v_mfma_f32_16x16x32_bf16 v[160:163], v[96:99], v[72:75], v[160:163]
  v_mfma_f32_16x16x32_bf16 v[188:191], v[100:103], v[72:75], v[188:191]
  v_mfma_f32_16x16x32_bf16 v[216:219], v[104:107], v[72:75], v[216:219]
  s_add_u32 s24, s24, 47104
  s_cmp_eq_u32 s24, 141312
  s_cselect_b32 s24, 0, s24
  s_add_u32 s32, s32, 1
  s_branch gca_loop
gca_last:
  v_mfma_f32_16x16x32_bf16 v[108:111], v[92:95], v[48:51], v[108:111]
  v_mfma_f32_16x16x32_bf16 v[136:139], v[96:99], v[48:51], v[136:139]
  v_mfma_f32_16x16x32_bf16 v[164:167], v[100:103], v[48:51], v[164:167]
  v_mfma_f32_16x16x32_bf16 v[192:195], v[104:107], v[48:51], v[192:195]
  v_mfma_f32_16x16x32_bf16 v[112:115], v[92:95], v[52:55], v[112:115]
  v_mfma_f32_16x16x32_bf16 v[140:143], v[96:99], v[52:55], v[140:143]
  v_mfma_f32_16x16x32_bf16 v[168:171], v[100:103], v[52:55], v[168:171]
  v_mfma_f32_16x16x32_bf16 v[196:199], v[104:107], v[52:55], v[196:199]
  v_mfma_f32_16x16x32_bf16 v[116:119], v[92:95], v[56:59], v[116:119]
  v_mfma_f32_16x16x32_bf16 v[144:147], v[96:99], v[56:59], v[144:147]
  v_mfma_f32_16x16x32_bf16 v[172:175], v[100:103], v[56:59], v[172:175]
  v_mfma_f32_16x16x32_bf16 v[200:203], v[104:107], v[56:59], v[200:203]
  v_mfma_f32_16x16x32_bf16 v[120:123], v[92:95], v[60:63], v[120:123]
  v_mfma_f32_16x16x32_bf16 v[148:151], v[96:99], v[60:63], v[148:151]
  v_mfma_f32_16x16x32_bf16 v[176:179], v[100:103], v[60:63], v[176:179]
  v_mfma_f32_16x16x32_bf16 v[204:207], v[104:107], v[60:63], v[204:207]
  v_mfma_f32_16x16x32_bf16 v[124:127], v[92:95], v[64:67], v[124:127]
  v_mfma_f32_16x16x32_bf16 v[152:155], v[96:99], v[64:67], v[152:155]
  v_mfma_f32_16x16x32_bf16 v[180:183], v[100:103], v[64:67], v[180:183]
  v_mfma_f32_16x16x32_bf16 v[208:211], v[104:107], v[64:67], v[208:211]
  v_mfma_f32_16x16x32_bf16 v[128:131], v[92:95], v[68:71], v[128:131]
  v_mfma_f32_16x16x32_bf16 v[156:159], v[96:99], v[68:71], v[156:159]
  v_mfma_f32_16x16x32_bf16 v[184:187], v[100:103], v[68:71], v[184:187]
  v_mfma_f32_16x16x32_bf16 v[212:215], v[104:107], v[68:71], v[212:215]
  v_mfma_f32_16x16x32_bf16 v[132:135], v[92:95], v[72:75], v[132:135]
  v_mfma_f32_16x16x32_bf16 v[160:163], v[96:99], v[72:75], v[160:163]
  v_mfma_f32_16x16x32_bf16 v[188:191], v[100:103], v[72:75], v[188:191]
  v_mfma_f32_16x16x32_bf16 v[216:219], v[104:107], v[72:75], v[216:219]
gr_sp3:
  ds_read_b32 v220, v2 offset:8
  s_waitcnt lgkmcnt(0)
  v_readfirstlane_b32 s30, v220
  s_nop 0
  s_cmp_ge_u32 s30, 40
  s_cbranch_scc1 gr_sp3d
  s_sub_u32 s99, s99, 1
  s_cbranch_scc0 gr_sp3
  s_branch L_exit
gr_sp3d:
  v_cvt_pk_bf16_f32 v108, v108, v109
  v_cvt_pk_bf16_f32 v109, v110, v111
  ds_write_b64 v248, v[108:109] offset:0
  v_cvt_pk_bf16_f32 v112, v112, v113
  v_cvt_pk_bf16_f32 v113, v114, v115
  ds_write_b64 v248, v[112:113] offset:3328
  v_cvt_pk_bf16_f32 v116, v116, v117
  v_cvt_pk_bf16_f32 v117, v118, v119
  ds_write_b64 v248, v[116:117] offset:6656
  v_cvt_pk_bf16_f32 v120, v120, v121
  v_cvt_pk_bf16_f32 v121, v122, v123
  ds_write_b64 v248, v[120:121] offset:9984
  v_cvt_pk_bf16_f32 v124, v124, v125
  v_cvt_pk_bf16_f32 v125, v126, v127
  ds_write_b64 v248, v[124:125] offset:13312
  v_cvt_pk_bf16_f32 v128, v128, v129
  v_cvt_pk_bf16_f32 v129, v130, v131
  ds_write_b64 v248, v[128:129] offset:16640
  v_cvt_pk_bf16_f32 v132, v132, v133
  v_cvt_pk_bf16_f32 v133, v134, v135
  ds_write_b64 v248, v[132:133] offset:19968
  v_cvt_pk_bf16_f32 v136, v136, v137
  v_cvt_pk_bf16_f32 v137, v138, v139
  ds_write_b64 v249, v[136:137] offset:0
  v_cvt_pk_bf16_f32 v140, v140, v141
  v_cvt_pk_bf16_f32 v141, v142, v143
  ds_write_b64 v249, v[140:141] offset:3328
  v_cvt_pk_bf16_f32 v144, v144, v145
  v_cvt_pk_bf16_f32 v145, v146, v147
  ds_write_b64 v249, v[144:145] offset:6656
  v_cvt_pk_bf16_f32 v148, v148, v149
  v_cvt_pk_bf16_f32 v149, v150, v151
  ds_write_b64 v249, v[148:149] offset:9984
  v_cvt_pk_bf16_f32 v152, v152, v153
  v_cvt_pk_bf16_f32 v153, v154, v155
  ds_write_b64 v249, v[152:153] offset:13312
  v_cvt_pk_bf16_f32 v156, v156, v157
  v_cvt_pk_bf16_f32 v157, v158, v159
  ds_write_b64 v249, v[156:157] offset:16640
  v_cvt_pk_bf16_f32 v160, v160, v161
  v_cvt_pk_bf16_f32 v161, v162, v163
  ds_write_b64 v249, v[160:161] offset:19968
  v_cvt_pk_bf16_f32 v164, v164, v165
  v_cvt_pk_bf16_f32 v165, v166, v167
  ds_write_b64 v250, v[164:165] offset:0
  v_cvt_pk_bf16_f32 v168, v168, v169
  v_cvt_pk_bf16_f32 v169, v170, v171
  ds_write_b64 v250, v[168:169] offset:3328
  v_cvt_pk_bf16_f32 v172, v172, v173
  v_cvt_pk_bf16_f32 v173, v174, v175
  ds_write_b64 v250, v[172:173] offset:6656
  v_cvt_pk_bf16_f32 v176, v176, v177
  v_cvt_pk_bf16_f32 v177, v178, v179
  ds_write_b64 v250, v[176:177] offset:9984
  v_cvt_pk_bf16_f32 v180, v180, v181
  v_cvt_pk_bf16_f32 v181, v182, v183
  ds_write_b64 v250, v[180:181] offset:13312
  v_cvt_pk_bf16_f32 v184, v184, v185
  v_cvt_pk_bf16_f32 v185, v186, v187
  ds_write_b64 v250, v[184:185] offset:16640
  v_cvt_pk_bf16_f32 v188, v188, v189
  v_cvt_pk_bf16_f32 v189, v190, v191
  ds_write_b64 v250, v[188:189] offset:19968
  s_cmp_eq_u32 s33, 3
  s_cbranch_scc1 ge_nd
  v_cvt_pk_bf16_f32 v192, v192, v193
  v_cvt_pk_bf16_f32 v193, v194, v195
  ds_write_b64 v251, v[192:193] offset:0
  v_cvt_pk_bf16_f32 v196, v196, v197
  v_cvt_pk_bf16_f32 v197, v198, v199
  ds_write_b64 v251, v[196:197] offset:3328
  v_cvt_pk_bf16_f32 v200, v200, v201
  v_cvt_pk_bf16_f32 v201, v202, v203
  ds_write_b64 v251, v[200:201] offset:6656
  v_cvt_pk_bf16_f32 v204, v204, v205
  v_cvt_pk_bf16_f32 v205, v206, v207
  ds_write_b64 v251, v[204:205] offset:9984
  v_cvt_pk_bf16_f32 v208, v208, v209
  v_cvt_pk_bf16_f32 v209, v210, v211
  ds_write_b64 v251, v[208:209] offset:13312
  v_cvt_pk_bf16_f32 v212, v212, v213
  v_cvt_pk_bf16_f32 v213, v214, v215
  ds_write_b64 v251, v[212:213] offset:16640
  v_cvt_pk_bf16_f32 v216, v216, v217
  v_cvt_pk_bf16_f32 v217, v218, v219
  ds_write_b64 v251, v[216:217] offset:19968
ge_nd:
  s_waitcnt lgkmcnt(0)
  v_mov_b32 v2, 163584
  v_mov_b32 v3, 1
  s_mov_b64 exec, 1
  ds_add_u32 v2, v3 offset:12
  s_mov_b64 exec, -1
  s_branch L_att
L_idle:
  s_cmp_eq_u32 s33, 7
  s_cbranch_scc0 L_nz
  v_mov_b32 v2, 0
  v_lshlrev_b32 v3, 2, v1
  v_add_u32 v3, 163584, v3
  ds_write_b32 v3, v2
  s_cmp_eq_u32 s2, 0
  s_cbranch_scc0 L_nz2
  s_load_dwordx2 s[52:53], s[0:1], 80
  s_memrealtime s[54:55]
  s_waitcnt lgkmcnt(0)
  s_or_b32 s54, s54, 1
  v_mov_b32 v4, s54
  s_mov_b64 exec, 1
  global_store_dword v2, v4, s[52:53] sc1
  s_mov_b64 exec, -1
L_nz2:
  s_waitcnt lgkmcnt(0)
L_nz:
  s_and_b32 s24, s33, 3
  s_lshr_b32 s25, s33, 2
  v_and_b32 v227, 15, v1
  v_lshrrev_b32 v228, 4, v1
  v_lshlrev_b32 v229, 2, v228
  v_mov_b32 v232, 0xff800000
  v_add_u32 v230, 0, v229
  v_add_u32 v231, 9, v227
  v_cmp_ge_u32 vcc, v230, v231
  s_nop 1
  v_cndmask_b32_e64 v238, v232, 0, vcc
  v_cmp_le_u32 s[22:23], v230, v227
  v_add_u32 v231, 7, v230
  v_cmp_ge_u32 vcc, v231, v227
  s_nop 1
  s_and_b64 vcc, vcc, s[22:23]
  v_cndmask_b32_e64 v242, v232, 0, vcc
  v_add_u32 v230, 1, v229
  v_add_u32 v231, 9, v227
  v_cmp_ge_u32 vcc, v230, v231
  s_nop 1
  v_cndmask_b32_e64 v239, v232, 0, vcc
  v_cmp_le_u32 s[22:23], v230, v227
  v_add_u32 v231, 7, v230
  v_cmp_ge_u32 vcc, v231, v227
  s_nop 1
  s_and_b64 vcc, vcc, s[22:23]
  v_cndmask_b32_e64 v243, v232, 0, vcc
  v_add_u32 v230, 2, v229
  v_add_u32 v231, 9, v227
  v_cmp_ge_u32 vcc, v230, v231
  s_nop 1
  v_cndmask_b32_e64 v240, v232, 0, vcc
  v_cmp_le_u32 s[22:23], v230, v227
  v_add_u32 v231, 7, v230
  v_cmp_ge_u32 vcc, v231, v227
  s_nop 1
  s_and_b64 vcc, vcc, s[22:23]
  v_cndmask_b32_e64 v244, v232, 0, vcc
  v_add_u32 v230, 3, v229
  v_add_u32 v231, 9, v227
  v_cmp_ge_u32 vcc, v230, v231
  s_nop 1
  v_cndmask_b32_e64 v241, v232, 0, vcc
  v_cmp_le_u32 s[22:23], v230, v227
  v_add_u32 v231, 7, v230
  v_cmp_ge_u32 vcc, v231, v227
  s_nop 1
  s_and_b64 vcc, vcc, s[22:23]
  v_cndmask_b32_e64 v245, v232, 0, vcc
  v_cmp_gt_u32 vcc, 3, v228
  s_nop 1
  v_cndmask_b32 v255, 0, -1, vcc
  v_cmp_gt_u32 vcc, 2, v228
  s_nop 1
  v_cndmask_b32 v226, 0, -1, vcc
  s_mul_i32 s30, s24, 48
  v_lshlrev_b32 v229, 1, v227
  s_add_u32 s31, s25, 16
  v_add_u32 v229, s31, v229
  v_mul_u32_u24 v230, 208, v229
  v_lshl_add_u32 v230, v228, 4, v230
  v_add_u32 v246, s30, v230
  v_subrev_u32 v229, 32, v229
  v_max_i32 v229, 0, v229
  v_mul_u32_u24 v230, 208, v229
  v_lshl_add_u32 v230, v228, 4, v230
  v_add_u32 v247, s30, v230
  v_bfe_u32 v229, v1, 2, 2
  v_lshl_add_u32 v229, v228, 2, v229
  v_lshlrev_b32 v229, 1, v229
  v_add_u32 v229, s31, v229
  v_and_b32 v231, 3, v1
  v_lshlrev_b32 v231, 3, v231
  v_add_u32 v231, s30, v231
  v_mul_u32_u24 v230, 208, v229
  v_add_u32 v252, v230, v231
  v_subrev_u32 v229, 32, v229
  v_max_i32 v229, 0, v229
  v_mul_u32_u24 v230, 208, v229
  v_add_u32 v253, v230, v231
  v_lshlrev_b32 v229, 1, v227
  v_add_u32 v229, s25, v229
  v_mul_u32_u24 v229, 160, v229
  s_mul_i32 s30, s24, 40
  v_lshl_add_u32 v229, v228, 3, v229
  v_add_u32 v254, s30, v229
  v_add_u32 v254, 69888, v254
  s_barrier
  s_load_dwordx2 s[52:53], s[0:1], 80
  v_mov_b32 v2, 0
  s_waitcnt lgkmcnt(0)
gi_nn4:
  global_load_dword v3, v2, s[52:53] sc1
  s_waitcnt vmcnt(0)
  v_readfirstlane_b32 s36, v3
  s_nop 0
  s_sub_u32 s99, s99, 1
  s_cbranch_scc1 L_exit
  s_cmp_eq_u32 s36, 0
  s_cbranch_scc1 gi_nn4
  v_mov_b32 v2, 163584
  v_mov_b32 v3, s36
  ds_write_b32 v2, v3 offset:52
  s_waitcnt lgkmcnt(0)
L_wp:
  s_and_b32 s22, s2, 7
  s_mul_i32 s22, s22, 20
  s_lshr_b32 s51, s2, 3
  s_cmp_lt_u32 s51, 20
  s_cselect_b32 s23, 1, 0
  s_add_u32 s51, s51, s22
  s_mov_b32 s50, s23
  s_and_b32 s22, s2, 3
  s_mul_i32 s22, s22, 22
  s_lshr_b32 s23, s2, 3
  s_add_u32 s22, s22, s23
  s_lshr_b32 s20, s22, 2
  s_and_b32 s22, s22, 3
  s_and_b32 s21, s2, 4
  s_add_u32 s21, s21, s22
  s_mul_i32 s28, s20, 122880
  s_mul_i32 s22, s21, 160
  s_add_u32 s28, s28, s22
  s_sub_u32 s22, s33, 4
  s_lshl_b32 s22, s22, 6
  v_add_u32 v6, s22, v1
  v_lshlrev_b32 v7, 4, v6
  v_add_u32 v134, 69888, v7
  v_add_u32 v8, 0, v6
  v_mul_u32_u24 v9, 6554, v8
  v_lshrrev_b32 v9, 16, v9
  v_mul_u32_u24 v10, 10, v9
  v_sub_u32 v10, v8, v10
  v_mul_u32_u24 v9, 1280, v9
  v_lshl_add_u32 v135, v10, 4, v9
  v_add_u32 v8, 256, v6
  v_mul_u32_u24 v9, 6554, v8
  v_lshrrev_b32 v9, 16, v9
  v_mul_u32_u24 v10, 10, v9
  v_sub_u32 v10, v8, v10
  v_mul_u32_u24 v9, 1280, v9
  v_lshl_add_u32 v136, v10, 4, v9
  v_add_u32 v8, 512, v6
  v_mul_u32_u24 v9, 6554, v8
  v_lshrrev_b32 v9, 16, v9
  v_mul_u32_u24 v10, 10, v9
  v_sub_u32 v10, v8, v10
  v_mul_u32_u24 v9, 1280, v9
  v_lshl_add_u32 v137, v10, 4, v9
  v_add_u32 v8, 768, v6
  v_mul_u32_u24 v9, 6554, v8
  v_lshrrev_b32 v9, 16, v9
  v_mul_u32_u24 v10, 10, v9
  v_sub_u32 v10, v8, v10
  v_mul_u32_u24 v9, 1280, v9
  v_lshl_add_u32 v138, v10, 4, v9
  s_sub_u32 s22, s33, 4
  s_lshl_b32 s22, s22, 2
  v_mov_b32 v17, 163584
  v_add_u32 v17, s22, v17
  v_mov_b32 v18, 1
  v_lshrrev_b32 v10, 3, v1
  v_and_b32 v11, 7, v1
  v_and_b32 v12, 6, v10
  v_xor_b32 v11, v11, v12
  v_lshrrev_b32 v12, 2, v10
  v_lshlrev_b32 v12, 3, v12
  v_and_b32 v13, 3, v10
  v_add_u32 v12, v12, v13
  v_mul_u32_u24 v12, 1280, v12
  v_lshl_add_u32 v16, v11, 4, v12
  s_cmp_eq_u32 s50, 0
  s_cbranch_scc1 L_att
  s_mul_i32 s20, s51, 6554
  s_lshr_b32 s20, s20, 16
  s_mul_i32 s22, s20, 10
  s_sub_u32 s21, s51, s22
  v_lshrrev_b32 v10, 3, v1
  v_and_b32 v11, 7, v1
  v_and_b32 v12, 6, v10
  v_xor_b32 v11, v11, v12
  v_lshrrev_b32 v12, 2, v10
  v_lshlrev_b32 v12, 3, v12
  v_and_b32 v13, 3, v10
  v_add_u32 v12, v12, v13
  v_mul_u32_u24 v12, 1280, v12
  v_lshl_add_u32 v16, v11, 4, v12
  s_sub_u32 s27, s33, 4
  s_lshl_b32 s24, s21, 7
  s_mul_i32 s22, s27, 20480
  s_add_u32 s24, s24, s22
  s_lshl_b32 s25, s27, 11
  s_add_u32 s25, s25, 85248
  s_waitcnt lgkmcnt(0)
  s_mov_b32 s8, s62
  s_and_b32 s9, s63, 0xffff
  s_mov_b32 s10, 819200
  s_mov_b32 s11, 0x20000
  v_mov_b32 v8, 163584
hp_sp5:
  ds_read_b32 v10, v8 offset:8
  s_waitcnt lgkmcnt(0)
  v_readfirstlane_b32 s22, v10
  s_nop 0
  s_cmp_ge_u32 s22, 36
  s_cbranch_scc1 hp_sp5d
  s_sleep 1
  s_sub_u32 s99, s99, 1
  s_cbranch_scc0 hp_sp5
  s_branch L_exit
hp_sp5d:
  s_mov_b32 s26, 0
hp_wl:
  s_add_u32 m0, s25, 0
  s_add_u32 s23, s24, 0
  buffer_load_dwordx4 v16, s[8:11], s23 offen lds
  s_add_u32 m0, s25, 1024
  s_add_u32 s23, s24, 5120
  buffer_load_dwordx4 v16, s[8:11], s23 offen lds
  s_add_u32 s25, s25, 8192
  s_add_u32 s24, s24, 81920
  s_add_u32 s26, s26, 1
  s_cmp_lt_u32 s26, 9
  s_cbranch_scc1 hp_wl
  s_mov_b32 s29, s24
L_att:
  s_waitcnt lgkmcnt(0)
  s_add_u32 s38, s48, 0xa00000
  s_addc_u32 s39, s49, 0
  s_and_b32 s22, s2, 3
  s_mul_i32 s22, s22, 22
  s_lshr_b32 s23, s2, 3
  s_add_u32 s22, s22, s23
  s_lshr_b32 s20, s22, 2
  s_and_b32 s22, s22, 3
  s_and_b32 s21, s2, 4
  s_add_u32 s21, s21, s22
  s_mov_b32 s16, s48
  s_and_b32 s17, s49, 0xffff
  s_mov_b32 s18, 2621440
  s_mov_b32 s19, 0x20000
  v_mov_b32 v2, 163584
  v_mov_b32 v3, 1
ga_sp6:
  ds_read_b32 v6, v2 offset:12
  s_waitcnt lgkmcnt(0)
  v_readfirstlane_b32 s30, v6
  s_nop 0
  s_cmp_ge_u32 s30, 4
  s_cbranch_scc1 ga_sp6d
  s_sleep 1
  s_sub_u32 s99, s99, 1
  s_cbranch_scc0 ga_sp6
  s_branch L_exit
ga_sp6d:
  ds_read_b128 v[24:27], v246 offset:0
  ds_read_b128 v[28:31], v246 offset:6656
  ds_read_b128 v[32:35], v246 offset:13312
  ds_read_b128 v[36:39], v247 offset:23296
  ds_read_b128 v[40:43], v246 offset:23296
  ds_read_b128 v[44:47], v246 offset:29952
  ds_read_b128 v[48:51], v246 offset:36608
  ds_read_b64_tr_b16 v[52:53], v253 offset:46592
  ds_read_b64_tr_b16 v[60:61], v253 offset:46624
  ds_read_b64_tr_b16 v[54:55], v252 offset:46592
  ds_read_b64_tr_b16 v[62:63], v252 offset:46624
  ds_read_b64_tr_b16 v[56:57], v252 offset:53248
  ds_read_b64_tr_b16 v[64:65], v252 offset:53280
  ds_read_b64_tr_b16 v[58:59], v252 offset:59904
  ds_read_b64_tr_b16 v[66:67], v252 offset:59936
  s_mov_b32 s31, 0x3ea52b5c
  s_waitcnt lgkmcnt(8)
  v_and_b32 v24, v255, v24
  v_and_b32 v25, v255, v25
  v_and_b32 v26, v226, v26
  v_and_b32 v27, v226, v27
  v_and_b32 v28, v255, v28
  v_and_b32 v29, v255, v29
  v_and_b32 v30, v226, v30
  v_and_b32 v31, v226, v31
  v_and_b32 v32, v255, v32
  v_and_b32 v33, v255, v33
  v_and_b32 v34, v226, v34
  v_and_b32 v35, v226, v35
  s_nop 1
  s_cmp_eq_u32 s20, 0
  s_cbranch_scc0 ga_b0
  v_mov_b32 v128, 0xff800000
  v_mov_b32 v129, 0xff800000
  v_mov_b32 v130, 0xff800000
  v_mov_b32 v131, 0xff800000
  s_nop 1
  v_mfma_f32_16x16x32_bf16 v[68:71], v[36:39], v[24:27], v[128:131]
  s_branch ga_b1
ga_b0:
  v_mfma_f32_16x16x32_bf16 v[68:71], v[36:39], v[24:27], v[238:241]
ga_b1:
  v_mfma_f32_16x16x32_bf16 v[72:75], v[40:43], v[24:27], v[242:245]
  v_mfma_f32_16x16x32_bf16 v[76:79], v[40:43], v[28:31], v[238:241]
  v_mfma_f32_16x16x32_bf16 v[80:83], v[44:47], v[28:31], v[242:245]
  v_mfma_f32_16x16x32_bf16 v[84:87], v[44:47], v[32:35], v[238:241]
  v_mfma_f32_16x16x32_bf16 v[88:91], v[48:51], v[32:35], v[242:245]
  s_nop 7
  v_max3_f32 v128, v68, v69, v70
  v_max3_f32 v129, v71, v72, v73
  v_max3_f32 v128, v128, v74, v75
  v_max_f32 v128, v128, v129
  v_max3_f32 v130, v76, v77, v78
  v_max3_f32 v131, v79, v80, v81
  v_max3_f32 v130, v130, v82, v83
  v_max_f32 v130, v130, v131
  v_max3_f32 v132, v84, v85, v86
  v_max3_f32 v133, v87, v88, v89
  v_max3_f32 v132, v132, v90, v91
  v_max_f32 v132, v132, v133
  v_mov_b32 v129, v128
  v_mov_b32 v131, v130
  v_mov_b32 v133, v132
  s_nop 0
  v_permlane16_swap_b32 v128, v129
  v_permlane16_swap_b32 v130, v131
  v_permlane16_swap_b32 v132, v133
  v_max_f32 v128, v128, v129
  v_max_f32 v130, v130, v131
  v_max_f32 v132, v132, v133
  v_mov_b32 v129, v128
  v_mov_b32 v131, v130
  v_mov_b32 v133, v132
  s_nop 0
  v_permlane32_swap_b32 v128, v129
  v_permlane32_swap_b32 v130, v131
  v_permlane32_swap_b32 v132, v133
  v_max_f32 v128, v128, v129
  v_max_f32 v130, v130, v131
  v_max_f32 v132, v132, v133
  v_mul_f32 v128, s31, v128
  v_mul_f32 v130, s31, v130
  v_mul_f32 v132, s31, v132
  v_fma_f32 v68, v68, s31, -v128
  v_fma_f32 v69, v69, s31, -v128
  v_fma_f32 v70, v70, s31, -v128
  v_fma_f32 v71, v71, s31, -v128
  v_fma_f32 v72, v72, s31, -v128
  v_fma_f32 v73, v73, s31, -v128
  v_fma_f32 v74, v74, s31, -v128
  v_fma_f32 v75, v75, s31, -v128
  v_fma_f32 v76, v76, s31, -v130
  v_fma_f32 v77, v77, s31, -v130
  v_fma_f32 v78, v78, s31, -v130
  v_fma_f32 v79, v79, s31, -v130
  v_fma_f32 v80, v80, s31, -v130
  v_fma_f32 v81, v81, s31, -v130
  v_fma_f32 v82, v82, s31, -v130
  v_fma_f32 v83, v83, s31, -v130
  v_fma_f32 v84, v84, s31, -v132
  v_fma_f32 v85, v85, s31, -v132
  v_fma_f32 v86, v86, s31, -v132
  v_fma_f32 v87, v87, s31, -v132
  v_fma_f32 v88, v88, s31, -v132
  v_fma_f32 v89, v89, s31, -v132
  v_fma_f32 v90, v90, s31, -v132
  v_fma_f32 v91, v91, s31, -v132
  v_exp_f32 v68, v68
  v_exp_f32 v69, v69
  v_exp_f32 v70, v70
  v_exp_f32 v71, v71
  v_exp_f32 v72, v72
  v_exp_f32 v73, v73
  v_exp_f32 v74, v74
  v_exp_f32 v75, v75
  v_exp_f32 v76, v76
  v_exp_f32 v77, v77
  v_exp_f32 v78, v78
  v_exp_f32 v79, v79
  v_exp_f32 v80, v80
  v_exp_f32 v81, v81
  v_exp_f32 v82, v82
  v_exp_f32 v83, v83
  v_exp_f32 v84, v84
  v_exp_f32 v85, v85
  v_exp_f32 v86, v86
  v_exp_f32 v87, v87
  v_exp_f32 v88, v88
  v_exp_f32 v89, v89
  v_exp_f32 v90, v90
  v_exp_f32 v91, v91
  v_add_f32 v128, v68, v69
  v_add_f32 v129, v70, v71
  v_add_f32 v128, v128, v72
  v_add_f32 v129, v129, v73
  v_add_f32 v128, v128, v74
  v_add_f32 v129, v129, v75
  v_add_f32 v128, v128, v129
  v_add_f32 v130, v76, v77
  v_add_f32 v131, v78, v79
  v_add_f32 v130, v130, v80
  v_add_f32 v131, v131, v81
  v_add_f32 v130, v130, v82
  v_add_f32 v131, v131, v83
  v_add_f32 v130, v130, v131
  v_add_f32 v132, v84, v85
  v_add_f32 v133, v86, v87
  v_add_f32 v132, v132, v88
  v_add_f32 v133, v133, v89
  v_add_f32 v132, v132, v90
  v_add_f32 v133, v133, v91
  v_add_f32 v132, v132, v133
  v_mov_b32 v129, v128
  v_mov_b32 v131, v130
  v_mov_b32 v133, v132
  s_nop 0
  v_permlane16_swap_b32 v128, v129
  v_permlane16_swap_b32 v130, v131
  v_permlane16_swap_b32 v132, v133
  v_add_f32 v128, v128, v129
  v_add_f32 v130, v130, v131
  v_add_f32 v132, v132, v133
  v_mov_b32 v129, v128
  v_mov_b32 v131, v130
  v_mov_b32 v133, v132
  s_nop 0
  v_permlane32_swap_b32 v128, v129
  v_permlane32_swap_b32 v130, v131
  v_permlane32_swap_b32 v132, v133
  v_add_f32 v128, v128, v129
  v_add_f32 v130, v130, v131
  v_add_f32 v132, v132, v133
  v_rcp_f32 v128, v128
  v_rcp_f32 v130, v130
  v_rcp_f32 v132, v132
  s_nop 0
  v_mul_f32 v68, v68, v128
  v_mul_f32 v69, v69, v128
  v_mul_f32 v70, v70, v128
  v_mul_f32 v71, v71, v128
  v_mul_f32 v72, v72, v128
  v_mul_f32 v73, v73, v128
  v_mul_f32 v74, v74, v128
  v_mul_f32 v75, v75, v128
  v_mul_f32 v76, v76, v130
  v_mul_f32 v77, v77, v130
  v_mul_f32 v78, v78, v130
  v_mul_f32 v79, v79, v130
  v_mul_f32 v80, v80, v130
  v_mul_f32 v81, v81, v130
  v_mul_f32 v82, v82, v130
  v_mul_f32 v83, v83, v130
  v_mul_f32 v84, v84, v132
  v_mul_f32 v85, v85, v132
  v_mul_f32 v86, v86, v132
  v_mul_f32 v87, v87, v132
  v_mul_f32 v88, v88, v132
  v_mul_f32 v89, v89, v132
  v_mul_f32 v90, v90, v132
  v_mul_f32 v91, v91, v132
  v_cvt_pk_bf16_f32 v92, v68, v69
  v_cvt_pk_bf16_f32 v93, v70, v71
  v_cvt_pk_bf16_f32 v94, v72, v73
  v_cvt_pk_bf16_f32 v95, v74, v75
  v_cvt_pk_bf16_f32 v96, v76, v77
  v_cvt_pk_bf16_f32 v97, v78, v79
  v_cvt_pk_bf16_f32 v98, v80, v81
  v_cvt_pk_bf16_f32 v99, v82, v83
  v_cvt_pk_bf16_f32 v100, v84, v85
  v_cvt_pk_bf16_f32 v101, v86, v87
  v_cvt_pk_bf16_f32 v102, v88, v89
  v_cvt_pk_bf16_f32 v103, v90, v91
  s_waitcnt lgkmcnt(0)
  s_nop 1
  v_mfma_f32_16x16x32_bf16 v[104:107], v[52:55], v[92:95], 0
  v_mfma_f32_16x16x32_bf16 v[108:111], v[60:63], v[92:95], 0
  v_mfma_f32_16x16x32_bf16 v[112:115], v[54:57], v[96:99], 0
  v_mfma_f32_16x16x32_bf16 v[116:119], v[62:65], v[96:99], 0
  v_mfma_f32_16x16x32_bf16 v[120:123], v[56:59], v[100:103], 0
  v_mfma_f32_16x16x32_bf16 v[124:127], v[64:67], v[100:103], 0
  s_nop 7
  v_cvt_pk_bf16_f32 v104, v104, v105
  v_cvt_pk_bf16_f32 v105, v106, v107
  ds_write_b64 v254, v[104:105] offset:0
  v_cvt_pk_bf16_f32 v108, v108, v109
  v_cvt_pk_bf16_f32 v109, v110, v111
  v_cvt_pk_bf16_f32 v112, v112, v113
  v_cvt_pk_bf16_f32 v113, v114, v115
  ds_write_b64 v254, v[112:113] offset:5120
  v_cvt_pk_bf16_f32 v116, v116, v117
  v_cvt_pk_bf16_f32 v117, v118, v119
  v_cvt_pk_bf16_f32 v120, v120, v121
  v_cvt_pk_bf16_f32 v121, v122, v123
  ds_write_b64 v254, v[120:121] offset:10240
  v_cvt_pk_bf16_f32 v124, v124, v125
  v_cvt_pk_bf16_f32 v125, v126, v127
  s_mov_b64 exec, 0xffff
  ds_write_b64 v254, v[108:109] offset:32
  ds_write_b64 v254, v[116:117] offset:5152
  ds_write_b64 v254, v[124:125] offset:10272
  s_mov_b64 exec, -1
  s_waitcnt lgkmcnt(0)
  s_mov_b64 exec, 1
  ds_add_u32 v2, v3 offset:32
  s_mov_b64 exec, -1
ga_sp7:
  ds_read_b32 v6, v2 offset:32
  s_waitcnt lgkmcnt(0)
  v_readfirstlane_b32 s30, v6
  s_nop 0
  s_cmp_ge_u32 s30, 8
  s_cbranch_scc1 ga_sp7d
  s_sub_u32 s99, s99, 1
  s_cbranch_scc0 ga_sp7
  s_branch L_exit
ga_sp7d:
  s_cmp_lt_u32 s33, 4
  s_cbranch_scc1 ga_done
  ds_read_b128 v[24:27], v134 offset:0
  ds_read_b128 v[28:31], v134 offset:4096
  ds_read_b128 v[32:35], v134 offset:8192
  ds_read_b128 v[36:39], v134 offset:12288
  s_waitcnt lgkmcnt(0)
  buffer_store_dwordx4 v[24:27], v135, s[16:19], s28 offen sc1
  buffer_store_dwordx4 v[28:31], v136, s[16:19], s28 offen sc1
  buffer_store_dwordx4 v[32:35], v137, s[16:19], s28 offen sc1
  s_cmp_lt_u32 s33, 7
  s_cbranch_scc0 ga_st3
  buffer_store_dwordx4 v[36:39], v138, s[16:19], s28 offen sc1
ga_st3:
  s_mov_b64 exec, 1
  ds_add_u32 v2, v3 offset:56
  s_mov_b64 exec, -1
  s_cmp_eq_u32 s50, 0
  s_cbranch_scc1 L_nws
  s_sub_u32 s27, s33, 4
  s_lshl_b32 s25, s27, 11
  s_mov_b32 s24, s29
  s_mov_b32 s8, s62
  s_and_b32 s9, s63, 0xffff
  s_mov_b32 s10, 819200
  s_mov_b32 s11, 0x20000
  s_add_u32 m0, s25, 0
  s_add_u32 s23, s24, 0
  buffer_load_dwordx4 v16, s[8:11], s23 offen lds
  s_add_u32 m0, s25, 1024
  s_add_u32 s23, s24, 5120
  buffer_load_dwordx4 v16, s[8:11], s23 offen lds
  s_add_u32 s25, s25, 8192
  s_add_u32 s24, s24, 81920
L_nws:
ga_done:
  s_cmp_lt_u32 s33, 4
  s_cbranch_scc1 L_cw
  s_cmp_eq_u32 s50, 0
  s_cbranch_scc1 L_nw2
L_nw2:
  s_cmp_eq_u32 s50, 0
  s_cbranch_scc1 L_nt0
  s_waitcnt vmcnt(2)
  s_mov_b64 exec, 1
  ds_add_u32 v17, v18 offset:64
  s_mov_b64 exec, -1
  s_branch L_nt1
L_nt0:
  s_waitcnt vmcnt(0)
L_nt1:
  v_mov_b32 v2, 163584
  v_mov_b32 v3, 1
  s_mov_b64 exec, 1
  ds_add_rtn_u32 v4, v2, v3 offset:28
  ds_read_b32 v5, v2 offset:52
  s_mov_b64 exec, -1
  s_waitcnt lgkmcnt(0)
  v_readfirstlane_b32 s22, v4
  v_readfirstlane_b32 s36, v5
  s_nop 0
  s_cmp_eq_u32 s22, 3
  s_cbranch_scc0 L_nosig
  s_lshl_b32 s22, s20, 7
  s_lshl_b32 s23, s21, 2
  s_add_u32 s22, s22, s23
  s_add_u32 s22, s22, 8192
  v_mov_b32 v4, s22
  v_mov_b32 v5, s36
  s_mov_b64 exec, 1
  global_store_dword v4, v5, s[38:39] sc1
  s_mov_b64 exec, -1
L_nosig:
  s_cmp_eq_u32 s50, 0
  s_cbranch_scc1 L_exit
  s_waitcnt vmcnt(0)
  s_mov_b64 exec, 1
  ds_add_u32 v17, v18 offset:64
  s_mov_b64 exec, -1
  s_mul_i32 s20, s51, 6554
  s_lshr_b32 s20, s20, 16
  s_mul_i32 s22, s20, 10
  s_sub_u32 s21, s51, s22
  v_mov_b32 v8, 163584
  v_mov_b32 v9, 1
  s_sub_u32 s27, s33, 4
  s_lshl_b32 s22, s27, 2
  v_add_u32 v15, s22, v8
  v_lshrrev_b32 v10, 3, v1
  v_mul_u32_u24 v10, 1280, v10
  v_and_b32 v11, 7, v1
  v_lshrrev_b32 v12, 4, v1
  v_xor_b32 v11, v11, v12
  v_lshl_add_u32 v13, v11, 4, v10
  v_xor_b32 v14, 64, v13
  s_mul_i32 s22, s20, 163840
  s_mul_i32 s23, s27, 40960
  s_add_u32 s22, s22, s23
  s_add_u32 s23, s22, 0
  v_add_u32 v20, s23, v13
  s_add_u32 s23, s22, 9216
  v_add_u32 v21, s23, v14
  s_add_u32 s23, s22, 18432
  v_add_u32 v22, s23, v13
  s_add_u32 s23, s22, 27648
  v_add_u32 v23, s23, v14
  s_mov_b32 s12, s48
  s_and_b32 s13, s49, 0xffff
  s_mov_b32 s14, 2621440
  s_mov_b32 s15, 0x20000
  s_lshl_b32 s22, s20, 2
  s_mul_i32 s22, s22, 86
  s_lshr_b32 s22, s22, 8
  s_lshl_b32 s22, s22, 7
  s_add_u32 s22, s22, 8192
  v_min_u32 v10, 15, v1
  v_lshrrev_b32 v11, 3, v10
  v_lshlrev_b32 v11, 7, v11
  v_and_b32 v10, 7, v10
  v_lshl_add_u32 v10, v10, 2, v11
  v_add_u32 v10, s22, v10
  s_cmp_eq_u32 s27, 0
  s_cbranch_scc0 hm_np
hm_pl8:
  global_load_dword v11, v10, s[38:39] sc1
  s_waitcnt vmcnt(0)
  v_cmp_ne_u32 vcc, s36, v11
  s_nop 1
  s_cbranch_vccz hm_pl8d
  s_sleep 2
  s_sub_u32 s99, s99, 1
  s_cbranch_scc0 hm_pl8
  s_branch L_exit
hm_pl8d:
  s_mov_b64 exec, 1
  ds_add_u32 v8, v9 offset:96
  s_mov_b64 exec, -1
hm_np:
hm_sp9:
  ds_read_b32 v10, v8 offset:96
  s_waitcnt lgkmcnt(0)
  v_readfirstlane_b32 s22, v10
  s_nop 0
  s_cmp_ge_u32 s22, 1
  s_cbranch_scc1 hm_sp9d
  s_sleep 1
  s_sub_u32 s99, s99, 1
  s_cbranch_scc0 hm_sp9
  s_branch L_exit
hm_sp9d:
hm_sp10:
  ds_read_b32 v10, v8 offset:24
  s_waitcnt lgkmcnt(0)
  v_readfirstlane_b32 s22, v10
  s_nop 0
  s_cmp_ge_u32 s22, 4
  s_cbranch_scc1 hm_sp10d
  s_sub_u32 s99, s99, 1
  s_cbranch_scc0 hm_sp10
  s_branch L_exit
hm_sp10d:
hm_sp11:
  ds_read_b32 v10, v8 offset:56
  s_waitcnt lgkmcnt(0)
  v_readfirstlane_b32 s22, v10
  s_nop 0
  s_cmp_ge_u32 s22, 4
  s_cbranch_scc1 hm_sp11d
  s_sub_u32 s99, s99, 1
  s_cbranch_scc0 hm_sp11
  s_branch L_exit
hm_sp11d:
  s_setprio 3
  s_lshl_b32 s25, s27, 12
  s_mov_b32 s26, 0
hm_o1:
  s_mov_b32 m0, s25
  s_add_u32 s25, s25, 16384
  buffer_load_dwordx4 v20, s[12:15], s26 offen offset:0 sc1 lds
  buffer_load_dwordx4 v21, s[12:15], s26 offen offset:1024 sc1 lds
  buffer_load_dwordx4 v22, s[12:15], s26 offen offset:2048 sc1 lds
  buffer_load_dwordx4 v23, s[12:15], s26 offen offset:3072 sc1 lds
  s_add_u32 s26, s26, 128
  s_cmp_lt_u32 s26, 640
  s_cbranch_scc1 hm_o1
hm_o2:
  s_waitcnt vmcnt(16)
  s_mov_b64 exec, 1
  ds_add_u32 v15, v9 offset:80
  s_mov_b64 exec, -1
  s_mov_b32 m0, s25
  s_add_u32 s25, s25, 16384
  buffer_load_dwordx4 v20, s[12:15], s26 offen offset:0 sc1 lds
  buffer_load_dwordx4 v21, s[12:15], s26 offen offset:1024 sc1 lds
  buffer_load_dwordx4 v22, s[12:15], s26 offen offset:2048 sc1 lds
  buffer_load_dwordx4 v23, s[12:15], s26 offen offset:3072 sc1 lds
  s_add_u32 s26, s26, 128
  s_cmp_lt_u32 s26, 1024
  s_cbranch_scc1 hm_o2
  s_lshl_b32 s25, s27, 12
  s_waitcnt vmcnt(16)
  s_mov_b64 exec, 1
  ds_add_u32 v15, v9 offset:80
  s_mov_b64 exec, -1
hm_sp12:
  ds_read_b32 v10, v8 offset:60
  s_waitcnt lgkmcnt(0)
  v_readfirstlane_b32 s22, v10
  s_nop 0
  s_cmp_ge_u32 s22, 4
  s_cbranch_scc1 hm_sp12d
  s_sub_u32 s99, s99, 1
  s_cbranch_scc0 hm_sp12
  s_branch L_exit
hm_sp12d:
  s_mov_b32 m0, s25
  s_add_u32 s25, s25, 16384
  buffer_load_dwordx4 v20, s[12:15], s26 offen offset:0 sc1 lds
  buffer_load_dwordx4 v21, s[12:15], s26 offen offset:1024 sc1 lds
  buffer_load_dwordx4 v22, s[12:15], s26 offen offset:2048 sc1 lds
  buffer_load_dwordx4 v23, s[12:15], s26 offen offset:3072 sc1 lds
  s_add_u32 s26, s26, 128
  s_waitcnt vmcnt(16)
  s_mov_b64 exec, 1
  ds_add_u32 v15, v9 offset:80
  s_mov_b64 exec, -1
hm_sp13:
  ds_read_b32 v10, v8 offset:60
  s_waitcnt lgkmcnt(0)
  v_readfirstlane_b32 s22, v10
  s_nop 0
  s_cmp_ge_u32 s22, 8
  s_cbranch_scc1 hm_sp13d
  s_sub_u32 s99, s99, 1
  s_cbranch_scc0 hm_sp13
  s_branch L_exit
hm_sp13d:
  s_mov_b32 m0, s25
  s_add_u32 s25, s25, 16384
  buffer_load_dwordx4 v20, s[12:15], s26 offen offset:0 sc1 lds
  buffer_load_dwordx4 v21, s[12:15], s26 offen offset:1024 sc1 lds
  buffer_load_dwordx4 v22, s[12:15], s26 offen offset:2048 sc1 lds
  buffer_load_dwordx4 v23, s[12:15], s26 offen offset:3072 sc1 lds
  s_add_u32 s26, s26, 128
  s_waitcnt vmcnt(16)
  s_mov_b64 exec, 1
  ds_add_u32 v15, v9 offset:80
  s_mov_b64 exec, -1
  s_waitcnt vmcnt(12)
  s_mov_b64 exec, 1
  ds_add_u32 v15, v9 offset:80
  s_mov_b64 exec, -1
  s_waitcnt vmcnt(8)
  s_mov_b64 exec, 1
  ds_add_u32 v15, v9 offset:80
  s_mov_b64 exec, -1
  s_waitcnt vmcnt(4)
  s_mov_b64 exec, 1
  ds_add_u32 v15, v9 offset:80
  s_mov_b64 exec, -1
  s_waitcnt vmcnt(0)
  s_mov_b64 exec, 1
  ds_add_u32 v15, v9 offset:80
  s_mov_b64 exec, -1
  s_branch L_exit
L_cw:
  s_and_b32 s22, s2, 7
  s_mul_i32 s22, s22, 20
  s_lshr_b32 s51, s2, 3
  s_cmp_lt_u32 s51, 20
  s_cselect_b32 s23, 1, 0
  s_add_u32 s51, s51, s22
  s_cmp_eq_u32 s23, 0
  s_cbranch_scc1 L_exit
  s_branch L_g2c
L_ld0:
  s_waitcnt lgkmcnt(0)
  s_setprio 3
  s_and_b32 s22, s2, 3
  s_mul_i32 s22, s22, 22
  s_lshr_b32 s23, s2, 3
  s_add_u32 s22, s22, s23
  s_lshr_b32 s20, s22, 2
  s_and_b32 s22, s22, 3
  s_and_b32 s21, s2, 4
  s_add_u32 s21, s21, s22
  v_lshrrev_b32 v10, 5, v1
  v_and_b32 v11, 31, v1
  s_mul_i32 s22, s21, 160
  v_mul_u32_u24 v12, 3840, v10
  v_add_u32 v12, s22, v12
  v_lshlrev_b32 v13, 1, v10
  v_add_u32 v13, 0, v13
  v_xor_b32 v13, v13, v11
  v_mul_u32_u24 v14, 26, v13
  v_lshrrev_b32 v14, 8, v14
  v_mul_u32_u24 v15, 1120, v14
  v_lshl_add_u32 v15, v13, 4, v15
  v_add_u32 v15, v15, v12
  v_cmp_gt_u32 vcc, 30, v13
  v_mov_b32 v2, 0x80000000
  s_nop 0
  v_cndmask_b32 v2, v2, v15, vcc
  v_lshlrev_b32 v13, 1, v10
  v_add_u32 v13, 4, v13
  v_xor_b32 v13, v13, v11
  v_mul_u32_u24 v14, 26, v13
  v_lshrrev_b32 v14, 8, v14
  v_mul_u32_u24 v15, 1120, v14
  v_lshl_add_u32 v15, v13, 4, v15
  v_add_u32 v15, v15, v12
  v_cmp_gt_u32 vcc, 30, v13
  v_mov_b32 v3, 0x80000000
  s_nop 0
  v_cndmask_b32 v3, v3, v15, vcc
  v_lshlrev_b32 v13, 1, v10
  v_add_u32 v13, 8, v13
  v_xor_b32 v13, v13, v11
  v_mul_u32_u24 v14, 26, v13
  v_lshrrev_b32 v14, 8, v14
  v_mul_u32_u24 v15, 1120, v14
  v_lshl_add_u32 v15, v13, 4, v15
  v_add_u32 v15, v15, v12
  v_cmp_gt_u32 vcc, 30, v13
  v_mov_b32 v4, 0x80000000
  s_nop 0
  v_cndmask_b32 v4, v4, v15, vcc
  v_lshlrev_b32 v13, 1, v10
  v_add_u32 v13, 12, v13
  v_xor_b32 v13, v13, v11
  v_mul_u32_u24 v14, 26, v13
  v_lshrrev_b32 v14, 8, v14
  v_mul_u32_u24 v15, 1120, v14
  v_lshl_add_u32 v15, v13, 4, v15
  v_add_u32 v15, v15, v12
  v_cmp_gt_u32 vcc, 30, v13
  v_mov_b32 v5, 0x80000000
  s_nop 0
  v_cndmask_b32 v5, v5, v15, vcc
  v_add_u32 v20, 0, v2
  v_add_u32 v21, 6656, v3
  v_add_u32 v22, 28672, v4
  v_add_u32 v23, 35328, v5
  v_add_u32 v24, 15360, v2
  v_add_u32 v25, 22016, v3
  v_add_u32 v26, 44032, v4
  v_add_u32 v27, 50688, v5
  v_lshrrev_b32 v10, 3, v1
  v_mul_u32_u24 v10, 1280, v10
  v_and_b32 v11, 7, v1
  v_lshrrev_b32 v12, 4, v1
  v_xor_b32 v11, v11, v12
  v_lshl_add_u32 v6, v11, 4, v10
  v_xor_b32 v7, 64, v6
  s_mul_i32 s28, s20, 122880
  s_sub_u32 s27, s28, 20480
  s_max_i32 s27, s27, 0
  s_add_u32 s22, s27, 0
  v_add_u32 v52, s22, v6
  s_add_u32 s22, s27, 9216
  v_add_u32 v53, s22, v7
  s_add_u32 s22, s28, 0
  v_add_u32 v54, s22, v6
  s_add_u32 s22, s28, 9216
  v_add_u32 v55, s22, v7
  s_add_u32 s22, s28, 18432
  v_add_u32 v56, s22, v6
  s_add_u32 s22, s28, 27648
  v_add_u32 v57, s22, v7
  s_add_u32 s22, s28, 40960
  v_add_u32 v58, s22, v6
  s_add_u32 s22, s28, 50176
  v_add_u32 v59, s22, v7
  s_add_u32 s22, s28, 59392
  v_add_u32 v60, s22, v6
  s_add_u32 s22, s28, 68608
  v_add_u32 v61, s22, v7
  s_add_u32 s22, s28, 81920
  v_add_u32 v62, s22, v6
  s_add_u32 s22, s28, 91136
  v_add_u32 v63, s22, v7
  s_add_u32 s22, s28, 100352
  v_add_u32 v64, s22, v6
  s_add_u32 s22, s28, 109568
  v_add_u32 v65, s22, v7
  v_mov_b32 v8, 163584
  v_mov_b32 v9, 1
  s_and_b32 s22, s21, 3
  s_mul_i32 s22, s22, 5
  s_add_u32 s22, s22, 1
  s_lshr_b32 s22, s22, 1
  s_lshl_b32 s29, s20, 1
  s_add_u32 s29, s29, s22
  s_mul_i32 s22, s29, 26
  s_lshr_b32 s22, s22, 8
  s_mul_i32 s22, s22, 10
  s_sub_u32 s29, s29, s22
  s_mov_b32 s8, s40
  s_and_b32 s9, s41, 0xffff
  s_mov_b32 s10, 2621440
  s_mov_b32 s11, 0x20000
  s_mov_b32 s12, s42
  s_and_b32 s13, s43, 0xffff
  s_mov_b32 s14, 2457600
  s_mov_b32 s15, 0x20000
  s_mov_b32 s25, 0
  s_mov_b32 s24, 0
gl0_ll:
  s_mul_i32 s26, s29, 245760
  s_lshl_b32 s30, s29, 7
  s_cmp_lt_u32 s24, 3
  s_cbranch_scc1 gl0_nofree
  s_sub_u32 s23, s24, 2
  s_lshl_b32 s23, s23, 2
gl0_sp14:
  ds_read_b32 v10, v8 offset:8
  s_waitcnt lgkmcnt(0)
  v_readfirstlane_b32 s32, v10
  s_nop 0
  s_cmp_ge_u32 s32, s23
  s_cbranch_scc1 gl0_sp14d
  s_sleep 1
  s_sub_u32 s99, s99, 1
  s_cbranch_scc0 gl0_sp14
  s_branch L_exit
gl0_sp14d:
gl0_nofree:
  s_add_u32 m0, s25, 0
  s_nop 0
  buffer_load_dwordx4 v52, s[8:11], s30 offen offset:0  lds
  buffer_load_dwordx4 v53, s[8:11], s30 offen offset:1024  lds
  s_add_u32 m0, s25, 2048
  s_nop 0
  buffer_load_dwordx4 v54, s[8:11], s30 offen offset:0  lds
  buffer_load_dwordx4 v55, s[8:11], s30 offen offset:1024  lds
  buffer_load_dwordx4 v56, s[8:11], s30 offen offset:2048  lds
  buffer_load_dwordx4 v57, s[8:11], s30 offen offset:3072  lds
  s_add_u32 m0, s25, 6144
  s_nop 0
  buffer_load_dwordx4 v58, s[8:11], s30 offen offset:0  lds
  buffer_load_dwordx4 v59, s[8:11], s30 offen offset:1024  lds
  buffer_load_dwordx4 v60, s[8:11], s30 offen offset:2048  lds
  buffer_load_dwordx4 v61, s[8:11], s30 offen offset:3072  lds
  s_add_u32 m0, s25, 10240
  s_nop 0
  buffer_load_dwordx4 v62, s[8:11], s30 offen offset:0  lds
  s_cmp_eq_u32 s24, 0
  s_cbranch_scc0 gl0_sig
  s_barrier
  s_branch gl0_adv
gl0_sig:
  s_waitcnt vmcnt(11)
  s_mov_b64 exec, 1
  ds_add_u32 v8, v9 offset:0
  s_mov_b64 exec, -1
gl0_adv:
  s_add_u32 m0, s25, 10240
  s_nop 0
  buffer_load_dwordx4 v63, s[8:11], s30 offen offset:1024  lds
  buffer_load_dwordx4 v64, s[8:11], s30 offen offset:2048  lds
  buffer_load_dwordx4 v65, s[8:11], s30 offen offset:3072  lds
  s_add_u32 m0, s25, 14336
  s_nop 0
  buffer_load_dwordx4 v20, s[12:15], s26 offen offset:0  lds
  buffer_load_dwordx4 v21, s[12:15], s26 offen offset:1024  lds
  buffer_load_dwordx4 v22, s[12:15], s26 offen offset:2048  lds
  buffer_load_dwordx4 v23, s[12:15], s26 offen offset:3072  lds
  s_add_u32 m0, s25, 18432
  s_nop 0
  buffer_load_dwordx4 v24, s[12:15], s26 offen offset:0  lds
  buffer_load_dwordx4 v25, s[12:15], s26 offen offset:1024  lds
  buffer_load_dwordx4 v26, s[12:15], s26 offen offset:2048  lds
  buffer_load_dwordx4 v27, s[12:15], s26 offen offset:3072  lds
  s_add_u32 s29, s29, 1
  s_cmp_eq_u32 s29, 10
  s_cselect_b32 s29, 0, s29
  s_add_u32 s25, s25, 47104
  s_cmp_eq_u32 s25, 141312
  s_cselect_b32 s25, 0, s25
  s_add_u32 s24, s24, 1
  s_cmp_lt_u32 s24, 10
  s_cbranch_scc1 gl0_ll
  s_waitcnt vmcnt(0)
  s_mov_b64 exec, 1
  ds_add_u32 v8, v9 offset:0
  s_mov_b64 exec, -1
  s_setprio 0
  s_and_b32 s24, s33, 3
  s_lshr_b32 s25, s33, 2
  v_and_b32 v227, 15, v1
  v_lshrrev_b32 v228, 4, v1
  v_lshlrev_b32 v229, 2, v228
  v_mov_b32 v232, 0xff800000
  v_add_u32 v230, 0, v229
  v_add_u32 v231, 9, v227
  v_cmp_ge_u32 vcc, v230, v231
  s_nop 1
  v_cndmask_b32_e64 v238, v232, 0, vcc
  v_cmp_le_u32 s[22:23], v230, v227
  v_add_u32 v231, 7, v230
  v_cmp_ge_u32 vcc, v231, v227
  s_nop 1
  s_and_b64 vcc, vcc, s[22:23]
  v_cndmask_b32_e64 v242, v232, 0, vcc
  v_add_u32 v230, 1, v229
  v_add_u32 v231, 9, v227
  v_cmp_ge_u32 vcc, v230, v231
  s_nop 1
  v_cndmask_b32_e64 v239, v232, 0, vcc
  v_cmp_le_u32 s[22:23], v230, v227
  v_add_u32 v231, 7, v230
  v_cmp_ge_u32 vcc, v231, v227
  s_nop 1
  s_and_b64 vcc, vcc, s[22:23]
  v_cndmask_b32_e64 v243, v232, 0, vcc
  v_add_u32 v230, 2, v229
  v_add_u32 v231, 9, v227
  v_cmp_ge_u32 vcc, v230, v231
  s_nop 1
  v_cndmask_b32_e64 v240, v232, 0, vcc
  v_cmp_le_u32 s[22:23], v230, v227
  v_add_u32 v231, 7, v230
  v_cmp_ge_u32 vcc, v231, v227
  s_nop 1
  s_and_b64 vcc, vcc, s[22:23]
  v_cndmask_b32_e64 v244, v232, 0, vcc
  v_add_u32 v230, 3, v229
  v_add_u32 v231, 9, v227
  v_cmp_ge_u32 vcc, v230, v231
  s_nop 1
  v_cndmask_b32_e64 v241, v232, 0, vcc
  v_cmp_le_u32 s[22:23], v230, v227
  v_add_u32 v231, 7, v230
  v_cmp_ge_u32 vcc, v231, v227
  s_nop 1
  s_and_b64 vcc, vcc, s[22:23]
  v_cndmask_b32_e64 v245, v232, 0, vcc
  v_cmp_gt_u32 vcc, 3, v228
  s_nop 1
  v_cndmask_b32 v255, 0, -1, vcc
  v_cmp_gt_u32 vcc, 2, v228
  s_nop 1
  v_cndmask_b32 v226, 0, -1, vcc
  s_mul_i32 s30, s24, 48
  v_lshlrev_b32 v229, 1, v227
  s_add_u32 s31, s25, 16
  v_add_u32 v229, s31, v229
  v_mul_u32_u24 v230, 208, v229
  v_lshl_add_u32 v230, v228, 4, v230
  v_add_u32 v246, s30, v230
  v_subrev_u32 v229, 32, v229
  v_max_i32 v229, 0, v229
  v_mul_u32_u24 v230, 208, v229
  v_lshl_add_u32 v230, v228, 4, v230
  v_add_u32 v247, s30, v230
  v_bfe_u32 v229, v1, 2, 2
  v_lshl_add_u32 v229, v228, 2, v229
  v_lshlrev_b32 v229, 1, v229
  v_add_u32 v229, s31, v229
  v_and_b32 v231, 3, v1
  v_lshlrev_b32 v231, 3, v231
  v_add_u32 v231, s30, v231
  v_mul_u32_u24 v230, 208, v229
  v_add_u32 v252, v230, v231
  v_subrev_u32 v229, 32, v229
  v_max_i32 v229, 0, v229
  v_mul_u32_u24 v230, 208, v229
  v_add_u32 v253, v230, v231
  v_lshlrev_b32 v229, 1, v227
  v_add_u32 v229, s25, v229
  v_mul_u32_u24 v229, 160, v229
  s_mul_i32 s30, s24, 40
  v_lshl_add_u32 v229, v228, 3, v229
  v_add_u32 v254, s30, v229
  v_add_u32 v254, 69888, v254
  s_branch L_wp
L_ld1:
  s_waitcnt lgkmcnt(0)
  s_setprio 3
  s_and_b32 s22, s2, 3
  s_mul_i32 s22, s22, 22
  s_lshr_b32 s23, s2, 3
  s_add_u32 s22, s22, s23
  s_lshr_b32 s20, s22, 2
  s_and_b32 s22, s22, 3
  s_and_b32 s21, s2, 4
  s_add_u32 s21, s21, s22
  v_lshrrev_b32 v10, 5, v1
  v_and_b32 v11, 31, v1
  s_mul_i32 s22, s21, 160
  v_mul_u32_u24 v12, 3840, v10
  v_add_u32 v12, s22, v12
  v_lshlrev_b32 v13, 1, v10
  v_add_u32 v13, 0, v13
  v_xor_b32 v13, v13, v11
  v_mul_u32_u24 v14, 26, v13
  v_lshrrev_b32 v14, 8, v14
  v_mul_u32_u24 v15, 1120, v14
  v_lshl_add_u32 v15, v13, 4, v15
  v_add_u32 v15, v15, v12
  v_cmp_gt_u32 vcc, 30, v13
  v_mov_b32 v2, 0x80000000
  s_nop 0
  v_cndmask_b32 v2, v2, v15, vcc
  v_lshlrev_b32 v13, 1, v10
  v_add_u32 v13, 4, v13
  v_xor_b32 v13, v13, v11
  v_mul_u32_u24 v14, 26, v13
  v_lshrrev_b32 v14, 8, v14
  v_mul_u32_u24 v15, 1120, v14
  v_lshl_add_u32 v15, v13, 4, v15
  v_add_u32 v15, v15, v12
  v_cmp_gt_u32 vcc, 30, v13
  v_mov_b32 v3, 0x80000000
  s_nop 0
  v_cndmask_b32 v3, v3, v15, vcc
  v_lshlrev_b32 v13, 1, v10
  v_add_u32 v13, 8, v13
  v_xor_b32 v13, v13, v11
  v_mul_u32_u24 v14, 26, v13
  v_lshrrev_b32 v14, 8, v14
  v_mul_u32_u24 v15, 1120, v14
  v_lshl_add_u32 v15, v13, 4, v15
  v_add_u32 v15, v15, v12
  v_cmp_gt_u32 vcc, 30, v13
  v_mov_b32 v4, 0x80000000
  s_nop 0
  v_cndmask_b32 v4, v4, v15, vcc
  v_lshlrev_b32 v13, 1, v10
  v_add_u32 v13, 12, v13
  v_xor_b32 v13, v13, v11
  v_mul_u32_u24 v14, 26, v13
  v_lshrrev_b32 v14, 8, v14
  v_mul_u32_u24 v15, 1120, v14
  v_lshl_add_u32 v15, v13, 4, v15
  v_add_u32 v15, v15, v12
  v_cmp_gt_u32 vcc, 30, v13
  v_mov_b32 v5, 0x80000000
  s_nop 0
  v_cndmask_b32 v5, v5, v15, vcc
  v_add_u32 v28, 61440, v2
  v_add_u32 v29, 68096, v3
  v_add_u32 v30, 90112, v4
  v_add_u32 v31, 96768, v5
  v_add_u32 v32, 76800, v2
  v_add_u32 v33, 83456, v3
  v_add_u32 v34, 105472, v4
  v_add_u32 v35, 112128, v5
  v_add_u32 v36, 122880, v2
  v_add_u32 v37, 129536, v3
  v_add_u32 v38, 151552, v4
  v_add_u32 v39, 158208, v5
  v_add_u32 v40, 138240, v2
  v_add_u32 v41, 144896, v3
  v_add_u32 v42, 166912, v4
  v_add_u32 v43, 173568, v5
  v_add_u32 v44, 184320, v2
  v_add_u32 v45, 190976, v3
  v_add_u32 v46, 212992, v4
  v_add_u32 v47, 219648, v5
  v_add_u32 v48, 199680, v2
  v_add_u32 v49, 206336, v3
  v_add_u32 v50, 228352, v4
  v_add_u32 v51, 235008, v5
  v_mov_b32 v8, 163584
  v_mov_b32 v9, 1
  s_and_b32 s22, s21, 3
  s_mul_i32 s22, s22, 5
  s_add_u32 s22, s22, 1
  s_lshr_b32 s22, s22, 1
  s_lshl_b32 s29, s20, 1
  s_add_u32 s29, s29, s22
  s_mul_i32 s22, s29, 26
  s_lshr_b32 s22, s22, 8
  s_mul_i32 s22, s22, 10
  s_sub_u32 s29, s29, s22
  s_mov_b32 s8, s40
  s_and_b32 s9, s41, 0xffff
  s_mov_b32 s10, 2621440
  s_mov_b32 s11, 0x20000
  s_mov_b32 s12, s42
  s_and_b32 s13, s43, 0xffff
  s_mov_b32 s14, 2457600
  s_mov_b32 s15, 0x20000
  s_mov_b32 s25, 0
  s_mov_b32 s24, 0
gl1_ll:
  s_mul_i32 s26, s29, 245760
  s_lshl_b32 s30, s29, 7
  s_cmp_lt_u32 s24, 3
  s_cbranch_scc1 gl1_nofree
  s_sub_u32 s23, s24, 2
  s_lshl_b32 s23, s23, 2
gl1_sp15:
  ds_read_b32 v10, v8 offset:8
  s_waitcnt lgkmcnt(0)
  v_readfirstlane_b32 s32, v10
  s_nop 0
  s_cmp_ge_u32 s32, s23
  s_cbranch_scc1 gl1_sp15d
  s_sleep 1
  s_sub_u32 s99, s99, 1
  s_cbranch_scc0 gl1_sp15
  s_branch L_exit
gl1_sp15d:
gl1_nofree:
  s_add_u32 m0, s25, 22528
  s_nop 0
  buffer_load_dwordx4 v28, s[12:15], s26 offen offset:0  lds
  buffer_load_dwordx4 v29, s[12:15], s26 offen offset:1024  lds
  buffer_load_dwordx4 v30, s[12:15], s26 offen offset:2048  lds
  buffer_load_dwordx4 v31, s[12:15], s26 offen offset:3072  lds
  s_add_u32 m0, s25, 26624
  s_nop 0
  buffer_load_dwordx4 v32, s[12:15], s26 offen offset:0  lds
  buffer_load_dwordx4 v33, s[12:15], s26 offen offset:1024  lds
  buffer_load_dwordx4 v34, s[12:15], s26 offen offset:2048  lds
  buffer_load_dwordx4 v35, s[12:15], s26 offen offset:3072  lds
  s_add_u32 m0, s25, 30720
  s_nop 0
  buffer_load_dwordx4 v36, s[12:15], s26 offen offset:0  lds
  buffer_load_dwordx4 v37, s[12:15], s26 offen offset:1024  lds
  buffer_load_dwordx4 v38, s[12:15], s26 offen offset:2048  lds
  buffer_load_dwordx4 v39, s[12:15], s26 offen offset:3072  lds
  s_cmp_eq_u32 s24, 0
  s_cbranch_scc0 gl1_sig
  s_barrier
  s_branch gl1_adv
gl1_sig:
  s_waitcnt vmcnt(12)
  s_mov_b64 exec, 1
  ds_add_u32 v8, v9 offset:4
  s_mov_b64 exec, -1
gl1_adv:
  s_add_u32 m0, s25, 34816
  s_nop 0
  buffer_load_dwordx4 v40, s[12:15], s26 offen offset:0  lds
  buffer_load_dwordx4 v41, s[12:15], s26 offen offset:1024  lds
  buffer_load_dwordx4 v42, s[12:15], s26 offen offset:2048  lds
  buffer_load_dwordx4 v43, s[12:15], s26 offen offset:3072  lds
  s_add_u32 m0, s25, 38912
  s_nop 0
  buffer_load_dwordx4 v44, s[12:15], s26 offen offset:0  lds
  buffer_load_dwordx4 v45, s[12:15], s26 offen offset:1024  lds
  buffer_load_dwordx4 v46, s[12:15], s26 offen offset:2048  lds
  buffer_load_dwordx4 v47, s[12:15], s26 offen offset:3072  lds
  s_add_u32 m0, s25, 43008
  s_nop 0
  buffer_load_dwordx4 v48, s[12:15], s26 offen offset:0  lds
  buffer_load_dwordx4 v49, s[12:15], s26 offen offset:1024  lds
  buffer_load_dwordx4 v50, s[12:15], s26 offen offset:2048  lds
  buffer_load_dwordx4 v51, s[12:15], s26 offen offset:3072  lds
  s_add_u32 s29, s29, 1
  s_cmp_eq_u32 s29, 10
  s_cselect_b32 s29, 0, s29
  s_add_u32 s25, s25, 47104
  s_cmp_eq_u32 s25, 141312
  s_cselect_b32 s25, 0, s25
  s_add_u32 s24, s24, 1
  s_cmp_lt_u32 s24, 10
  s_cbranch_scc1 gl1_ll
  s_waitcnt vmcnt(0)
  s_mov_b64 exec, 1
  ds_add_u32 v8, v9 offset:4
  s_mov_b64 exec, -1
  s_setprio 0
  s_and_b32 s24, s33, 3
  s_lshr_b32 s25, s33, 2
  v_and_b32 v227, 15, v1
  v_lshrrev_b32 v228, 4, v1
  v_lshlrev_b32 v229, 2, v228
  v_mov_b32 v232, 0xff800000
  v_add_u32 v230, 0, v229
  v_add_u32 v231, 9, v227
  v_cmp_ge_u32 vcc, v230, v231
  s_nop 1
  v_cndmask_b32_e64 v238, v232, 0, vcc
  v_cmp_le_u32 s[22:23], v230, v227
  v_add_u32 v231, 7, v230
  v_cmp_ge_u32 vcc, v231, v227
  s_nop 1
  s_and_b64 vcc, vcc, s[22:23]
  v_cndmask_b32_e64 v242, v232, 0, vcc
  v_add_u32 v230, 1, v229
  v_add_u32 v231, 9, v227
  v_cmp_ge_u32 vcc, v230, v231
  s_nop 1
  v_cndmask_b32_e64 v239, v232, 0, vcc
  v_cmp_le_u32 s[22:23], v230, v227
  v_add_u32 v231, 7, v230
  v_cmp_ge_u32 vcc, v231, v227
  s_nop 1
  s_and_b64 vcc, vcc, s[22:23]
  v_cndmask_b32_e64 v243, v232, 0, vcc
  v_add_u32 v230, 2, v229
  v_add_u32 v231, 9, v227
  v_cmp_ge_u32 vcc, v230, v231
  s_nop 1
  v_cndmask_b32_e64 v240, v232, 0, vcc
  v_cmp_le_u32 s[22:23], v230, v227
  v_add_u32 v231, 7, v230
  v_cmp_ge_u32 vcc, v231, v227
  s_nop 1
  s_and_b64 vcc, vcc, s[22:23]
  v_cndmask_b32_e64 v244, v232, 0, vcc
  v_add_u32 v230, 3, v229
  v_add_u32 v231, 9, v227
  v_cmp_ge_u32 vcc, v230, v231
  s_nop 1
  v_cndmask_b32_e64 v241, v232, 0, vcc
  v_cmp_le_u32 s[22:23], v230, v227
  v_add_u32 v231, 7, v230
  v_cmp_ge_u32 vcc, v231, v227
  s_nop 1
  s_and_b64 vcc, vcc, s[22:23]
  v_cndmask_b32_e64 v245, v232, 0, vcc
  v_cmp_gt_u32 vcc, 3, v228
  s_nop 1
  v_cndmask_b32 v255, 0, -1, vcc
  v_cmp_gt_u32 vcc, 2, v228
  s_nop 1
  v_cndmask_b32 v226, 0, -1, vcc
  s_mul_i32 s30, s24, 48
  v_lshlrev_b32 v229, 1, v227
  s_add_u32 s31, s25, 16
  v_add_u32 v229, s31, v229
  v_mul_u32_u24 v230, 208, v229
  v_lshl_add_u32 v230, v228, 4, v230
  v_add_u32 v246, s30, v230
  v_subrev_u32 v229, 32, v229
  v_max_i32 v229, 0, v229
  v_mul_u32_u24 v230, 208, v229
  v_lshl_add_u32 v230, v228, 4, v230
  v_add_u32 v247, s30, v230
  v_bfe_u32 v229, v1, 2, 2
  v_lshl_add_u32 v229, v228, 2, v229
  v_lshlrev_b32 v229, 1, v229
  v_add_u32 v229, s31, v229
  v_and_b32 v231, 3, v1
  v_lshlrev_b32 v231, 3, v231
  v_add_u32 v231, s30, v231
  v_mul_u32_u24 v230, 208, v229
  v_add_u32 v252, v230, v231
  v_subrev_u32 v229, 32, v229
  v_max_i32 v229, 0, v229
  v_mul_u32_u24 v230, 208, v229
  v_add_u32 v253, v230, v231
  v_lshlrev_b32 v229, 1, v227
  v_add_u32 v229, s25, v229
  v_mul_u32_u24 v229, 160, v229
  s_mul_i32 s30, s24, 40
  v_lshl_add_u32 v229, v228, 3, v229
  v_add_u32 v254, s30, v229
  v_add_u32 v254, 69888, v254
  s_branch L_wp
L_g2c:
  v_mov_b32 v2, 163584
  v_mov_b32 v3, 1
  v_and_b32 v10, 15, v1
  v_lshrrev_b32 v11, 4, v1
  v_lshrrev_b32 v12, 1, v11
  v_lshlrev_b32 v12, 4, v12
  v_and_b32 v13, 1, v11
  v_lshl_add_u32 v12, v13, 2, v12
  v_lshrrev_b32 v13, 2, v10
  v_add_u32 v12, v12, v13
  v_bfe_u32 v13, v12, 1, 2
  s_and_b32 s22, s33, 1
  s_lshl_b32 s22, s22, 1
  v_xor_b32 v13, s22, v13
  v_lshlrev_b32 v13, 5, v13
  v_lshl_add_u32 v13, v12, 7, v13
  v_and_b32 v14, 3, v1
  v_lshl_add_u32 v8, v14, 3, v13
  v_xor_b32 v9, 32, v8
  v_add_u32 v4, 85248, v8
  v_add_u32 v5, 85248, v9
  v_add_u32 v6, 40960, v4
  v_add_u32 v7, 40960, v5
hf_sp16:
  ds_read_b128 v[10:13], v2 offset:64
  s_waitcnt lgkmcnt(0)
  v_min_u32 v10, v10, v11
  v_min3_u32 v10, v10, v12, v13
  s_nop 0
  v_readfirstlane_b32 s22, v10
  s_nop 0
  s_cmp_ge_u32 s22, 1
  s_cbranch_scc1 hf_sp16d
  s_sub_u32 s99, s99, 1
  s_cbranch_scc0 hf_sp16
  s_branch L_exit
hf_sp16d:
  ds_read_b64_tr_b16 v[96:97], v4 offset:0
  ds_read_b64_tr_b16 v[98:99], v4 offset:1024
  ds_read_b64_tr_b16 v[100:101], v5 offset:0
  ds_read_b64_tr_b16 v[102:103], v5 offset:1024
  ds_read_b64_tr_b16 v[104:105], v4 offset:4096
  ds_read_b64_tr_b16 v[106:107], v4 offset:5120
  ds_read_b64_tr_b16 v[108:109], v5 offset:4096
  ds_read_b64_tr_b16 v[110:111], v5 offset:5120
  ds_read_b64_tr_b16 v[112:113], v4 offset:8192
  ds_read_b64_tr_b16 v[114:115], v4 offset:9216
  ds_read_b64_tr_b16 v[116:117], v5 offset:8192
  ds_read_b64_tr_b16 v[118:119], v5 offset:9216
  ds_read_b64_tr_b16 v[120:121], v4 offset:12288
  ds_read_b64_tr_b16 v[122:123], v4 offset:13312
  ds_read_b64_tr_b16 v[124:125], v5 offset:12288
  ds_read_b64_tr_b16 v[126:127], v5 offset:13312
  ds_read_b64_tr_b16 v[128:129], v4 offset:16384
  ds_read_b64_tr_b16 v[130:131], v4 offset:17408
  ds_read_b64_tr_b16 v[132:133], v5 offset:16384
  ds_read_b64_tr_b16 v[134:135], v5 offset:17408
  ds_read_b64_tr_b16 v[136:137], v4 offset:20480
  ds_read_b64_tr_b16 v[138:139], v4 offset:21504
  ds_read_b64_tr_b16 v[140:141], v5 offset:20480
  ds_read_b64_tr_b16 v[142:143], v5 offset:21504
  ds_read_b64_tr_b16 v[144:145], v4 offset:24576
  ds_read_b64_tr_b16 v[146:147], v4 offset:25600
  ds_read_b64_tr_b16 v[148:149], v5 offset:24576
  ds_read_b64_tr_b16 v[150:151], v5 offset:25600
  ds_read_b64_tr_b16 v[152:153], v4 offset:28672
  ds_read_b64_tr_b16 v[154:155], v4 offset:29696
  ds_read_b64_tr_b16 v[156:157], v5 offset:28672
  ds_read_b64_tr_b16 v[158:159], v5 offset:29696
  ds_read_b64_tr_b16 v[160:161], v4 offset:32768
  ds_read_b64_tr_b16 v[162:163], v4 offset:33792
  ds_read_b64_tr_b16 v[164:165], v5 offset:32768
  ds_read_b64_tr_b16 v[166:167], v5 offset:33792
  ds_read_b64_tr_b16 v[168:169], v4 offset:36864
  ds_read_b64_tr_b16 v[170:171], v4 offset:37888
  ds_read_b64_tr_b16 v[172:173], v5 offset:36864
  ds_read_b64_tr_b16 v[174:175], v5 offset:37888
  ds_read_b64_tr_b16 v[176:177], v6 offset:0
  ds_read_b64_tr_b16 v[178:179], v6 offset:1024
  ds_read_b64_tr_b16 v[180:181], v7 offset:0
  ds_read_b64_tr_b16 v[182:183], v7 offset:1024
  ds_read_b64_tr_b16 v[184:185], v6 offset:4096
  ds_read_b64_tr_b16 v[186:187], v6 offset:5120
  ds_read_b64_tr_b16 v[188:189], v7 offset:4096
  ds_read_b64_tr_b16 v[190:191], v7 offset:5120
  ds_read_b64_tr_b16 v[192:193], v6 offset:8192
  ds_read_b64_tr_b16 v[194:195], v6 offset:9216
  ds_read_b64_tr_b16 v[196:197], v7 offset:8192
  ds_read_b64_tr_b16 v[198:199], v7 offset:9216
  ds_read_b64_tr_b16 v[200:201], v6 offset:12288
  ds_read_b64_tr_b16 v[202:203], v6 offset:13312
  ds_read_b64_tr_b16 v[204:205], v7 offset:12288
  ds_read_b64_tr_b16 v[206:207], v7 offset:13312
  ds_read_b64_tr_b16 v[208:209], v6 offset:16384
  ds_read_b64_tr_b16 v[210:211], v6 offset:17408
  ds_read_b64_tr_b16 v[212:213], v7 offset:16384
  ds_read_b64_tr_b16 v[214:215], v7 offset:17408
  ds_read_b64_tr_b16 v[216:217], v6 offset:20480
  ds_read_b64_tr_b16 v[218:219], v6 offset:21504
  ds_read_b64_tr_b16 v[220:221], v7 offset:20480
  ds_read_b64_tr_b16 v[222:223], v7 offset:21504
  ds_read_b64_tr_b16 v[224:225], v6 offset:24576
  ds_read_b64_tr_b16 v[226:227], v6 offset:25600
  ds_read_b64_tr_b16 v[228:229], v7 offset:24576
  ds_read_b64_tr_b16 v[230:231], v7 offset:25600
  ds_read_b64_tr_b16 v[232:233], v6 offset:28672
  ds_read_b64_tr_b16 v[234:235], v6 offset:29696
  ds_read_b64_tr_b16 v[236:237], v7 offset:28672
  ds_read_b64_tr_b16 v[238:239], v7 offset:29696
hf_sp17:
  ds_read_b128 v[10:13], v2 offset:64
  s_waitcnt lgkmcnt(0)
  v_min_u32 v10, v10, v11
  v_min3_u32 v10, v10, v12, v13
  s_nop 0
  v_readfirstlane_b32 s22, v10
  s_nop 0
  s_cmp_ge_u32 s22, 2
  s_cbranch_scc1 hf_sp17d
  s_sub_u32 s99, s99, 1
  s_cbranch_scc0 hf_sp17
  s_branch L_exit
hf_sp17d:
  ds_read_b64_tr_b16 v[240:241], v8 offset:0
  ds_read_b64_tr_b16 v[242:243], v8 offset:1024
  ds_read_b64_tr_b16 v[244:245], v9 offset:0
  ds_read_b64_tr_b16 v[246:247], v9 offset:1024
  ds_read_b64_tr_b16 v[248:249], v8 offset:4096
  ds_read_b64_tr_b16 v[250:251], v8 offset:5120
  ds_read_b64_tr_b16 v[252:253], v9 offset:4096
  ds_read_b64_tr_b16 v[254:255], v9 offset:5120
  s_waitcnt lgkmcnt(0)
  s_mov_b64 exec, 1
  ds_add_u32 v2, v3 offset:24
  s_mov_b64 exec, -1
  s_load_dwordx2 s[40:41], s[0:1], 72
  s_mul_i32 s20, s51, 6554
  s_lshr_b32 s20, s20, 16
  s_mul_i32 s22, s20, 10
  s_sub_u32 s21, s51, s22
  v_mov_b32 v2, 163584
  v_mov_b32 v3, 1
  v_and_b32 v10, 15, v1
  v_lshrrev_b32 v11, 4, v1
  v_lshrrev_b32 v12, 1, v10
  v_xor_b32 v13, v11, v12
  v_lshlrev_b32 v14, 7, v10
  v_lshl_add_u32 v4, v13, 4, v14
  s_lshr_b32 s22, s33, 1
  s_lshl_b32 s22, s22, 13
  v_add_u32 v4, s22, v4
  v_xor_b32 v5, 64, v4
  v_add_u32 v6, 49152, v4
  v_add_u32 v7, 49152, v5
  v_add_u32 v8, 98304, v4
  v_add_u32 v9, 98304, v5
  v_mov_b32 v64, 0
  v_mov_b32 v65, 0
  v_mov_b32 v66, 0
  v_mov_b32 v67, 0
  v_mov_b32 v68, 0
  v_mov_b32 v69, 0
  v_mov_b32 v70, 0
  v_mov_b32 v71, 0
  v_mov_b32 v72, 0
  v_mov_b32 v73, 0
  v_mov_b32 v74, 0
  v_mov_b32 v75, 0
  v_mov_b32 v76, 0
  v_mov_b32 v77, 0
  v_mov_b32 v78, 0
  v_mov_b32 v79, 0
  v_mov_b32 v80, 0
  v_mov_b32 v81, 0
  v_mov_b32 v82, 0
  v_mov_b32 v83, 0
  v_mov_b32 v84, 0
  v_mov_b32 v85, 0
  v_mov_b32 v86, 0
  v_mov_b32 v87, 0
  v_mov_b32 v88, 0
  v_mov_b32 v89, 0
  v_mov_b32 v90, 0
  v_mov_b32 v91, 0
  v_mov_b32 v92, 0
  v_mov_b32 v93, 0
  v_mov_b32 v94, 0
  v_mov_b32 v95, 0
  s_waitcnt lgkmcnt(0)
  s_mov_b32 s8, s40
  s_and_b32 s9, s41, 0xffff
  s_mov_b32 s10, 5242880
  s_mov_b32 s11, 0x20000
hc_sp18:
  ds_read_b128 v[10:13], v2 offset:80
  s_waitcnt lgkmcnt(0)
  v_min_u32 v10, v10, v11
  v_min3_u32 v10, v10, v12, v13
  s_nop 0
  v_readfirstlane_b32 s22, v10
  s_nop 0
  s_cmp_ge_u32 s22, 1
  s_cbranch_scc1 hc_sp18d
  s_sleep 1
  s_sub_u32 s99, s99, 1
  s_cbranch_scc0 hc_sp18
  s_branch L_exit
hc_sp18d:
  ds_read_b128 v[16:19], v4 offset:0
  ds_read_b128 v[20:23], v4 offset:2048
  ds_read_b128 v[24:27], v4 offset:4096
  ds_read_b128 v[28:31], v4 offset:6144
  ds_read_b128 v[10:13], v2 offset:80
  ds_read_b128 v[32:35], v5 offset:0
  ds_read_b128 v[36:39], v5 offset:2048
  ds_read_b128 v[40:43], v5 offset:4096
  ds_read_b128 v[44:47], v5 offset:6144
  s_waitcnt lgkmcnt(4)
  v_min_u32 v10, v10, v11
  v_min3_u32 v10, v10, v12, v13
  s_nop 0
  v_readfirstlane_b32 s22, v10
  s_nop 0
  s_cmp_ge_u32 s22, 2
  s_cbranch_scc1 hc_r19
hc_sp20:
  ds_read_b128 v[10:13], v2 offset:80
  s_waitcnt lgkmcnt(0)
  v_min_u32 v10, v10, v11
  v_min3_u32 v10, v10, v12, v13
  s_nop 0
  v_readfirstlane_b32 s22, v10
  s_nop 0
  s_cmp_ge_u32 s22, 2
  s_cbranch_scc1 hc_sp20d
  s_sub_u32 s99, s99, 1
  s_cbranch_scc0 hc_sp20
  s_branch L_exit
hc_sp20d:
hc_r19:
  v_mfma_f32_16x16x32_bf16 v[64:67], v[96:99], v[16:19], v[64:67]
  ds_read_b128 v[48:51], v4 offset:16384
  v_mfma_f32_16x16x32_bf16 v[68:71], v[96:99], v[20:23], v[68:71]
  ds_read_b128 v[52:55], v4 offset:18432
  v_mfma_f32_16x16x32_bf16 v[72:75], v[96:99], v[24:27], v[72:75]
  ds_read_b128 v[56:59], v4 offset:20480
  v_mfma_f32_16x16x32_bf16 v[76:79], v[96:99], v[28:31], v[76:79]
  ds_read_b128 v[60:63], v4 offset:22528
  v_mfma_f32_16x16x32_bf16 v[80:83], v[100:103], v[16:19], v[80:83]
  v_mfma_f32_16x16x32_bf16 v[84:87], v[100:103], v[20:23], v[84:87]
  v_mfma_f32_16x16x32_bf16 v[88:91], v[100:103], v[24:27], v[88:91]
  v_mfma_f32_16x16x32_bf16 v[92:95], v[100:103], v[28:31], v[92:95]
  s_waitcnt lgkmcnt(4)
  s_mov_b64 exec, 1
  ds_add_u32 v2, v3 offset:60
  s_mov_b64 exec, -1
  s_nop 0
  v_mfma_f32_16x16x32_bf16 v[64:67], v[104:107], v[32:35], v[64:67]
  ds_read_b128 v[10:13], v2 offset:80
  v_mfma_f32_16x16x32_bf16 v[68:71], v[104:107], v[36:39], v[68:71]
  ds_read_b128 v[16:19], v5 offset:16384
  v_mfma_f32_16x16x32_bf16 v[72:75], v[104:107], v[40:43], v[72:75]
  ds_read_b128 v[20:23], v5 offset:18432
  v_mfma_f32_16x16x32_bf16 v[76:79], v[104:107], v[44:47], v[76:79]
  ds_read_b128 v[24:27], v5 offset:20480
  v_mfma_f32_16x16x32_bf16 v[80:83], v[108:111], v[32:35], v[80:83]
  ds_read_b128 v[28:31], v5 offset:22528
  v_mfma_f32_16x16x32_bf16 v[84:87], v[108:111], v[36:39], v[84:87]
  v_mfma_f32_16x16x32_bf16 v[88:91], v[108:111], v[40:43], v[88:91]
  v_mfma_f32_16x16x32_bf16 v[92:95], v[108:111], v[44:47], v[92:95]
  s_waitcnt lgkmcnt(4)
  v_min_u32 v10, v10, v11
  v_min3_u32 v10, v10, v12, v13
  s_nop 0
  v_readfirstlane_b32 s22, v10
  s_nop 0
  s_cmp_ge_u32 s22, 3
  s_cbranch_scc1 hc_r21
hc_sp22:
  ds_read_b128 v[10:13], v2 offset:80
  s_waitcnt lgkmcnt(0)
  v_min_u32 v10, v10, v11
  v_min3_u32 v10, v10, v12, v13
  s_nop 0
  v_readfirstlane_b32 s22, v10
  s_nop 0
  s_cmp_ge_u32 s22, 3
  s_cbranch_scc1 hc_sp22d
  s_sub_u32 s99, s99, 1
  s_cbranch_scc0 hc_sp22
  s_branch L_exit
hc_sp22d:
hc_r21:
  v_mfma_f32_16x16x32_bf16 v[64:67], v[112:115], v[48:51], v[64:67]
  ds_read_b128 v[32:35], v4 offset:32768
  v_mfma_f32_16x16x32_bf16 v[68:71], v[112:115], v[52:55], v[68:71]
  ds_read_b128 v[36:39], v4 offset:34816
  v_mfma_f32_16x16x32_bf16 v[72:75], v[112:115], v[56:59], v[72:75]
  ds_read_b128 v[40:43], v4 offset:36864
  v_mfma_f32_16x16x32_bf16 v[76:79], v[112:115], v[60:63], v[76:79]
  ds_read_b128 v[44:47], v4 offset:38912
  v_mfma_f32_16x16x32_bf16 v[80:83], v[116:119], v[48:51], v[80:83]
  v_mfma_f32_16x16x32_bf16 v[84:87], v[116:119], v[52:55], v[84:87]
  v_mfma_f32_16x16x32_bf16 v[88:91], v[116:119], v[56:59], v[88:91]
  v_mfma_f32_16x16x32_bf16 v[92:95], v[116:119], v[60:63], v[92:95]
  s_waitcnt lgkmcnt(4)
  s_mov_b64 exec, 1
  ds_add_u32 v2, v3 offset:60
  s_mov_b64 exec, -1
  s_nop 0
  v_mfma_f32_16x16x32_bf16 v[64:67], v[120:123], v[16:19], v[64:67]
  ds_read_b128 v[10:13], v2 offset:80
  v_mfma_f32_16x16x32_bf16 v[68:71], v[120:123], v[20:23], v[68:71]
  ds_read_b128 v[48:51], v5 offset:32768
  v_mfma_f32_16x16x32_bf16 v[72:75], v[120:123], v[24:27], v[72:75]
  ds_read_b128 v[52:55], v5 offset:34816
  v_mfma_f32_16x16x32_bf16 v[76:79], v[120:123], v[28:31], v[76:79]
  ds_read_b128 v[56:59], v5 offset:36864
  v_mfma_f32_16x16x32_bf16 v[80:83], v[124:127], v[16:19], v[80:83]
  ds_read_b128 v[60:63], v5 offset:38912
  v_mfma_f32_16x16x32_bf16 v[84:87], v[124:127], v[20:23], v[84:87]
  v_mfma_f32_16x16x32_bf16 v[88:91], v[124:127], v[24:27], v[88:91]
  v_mfma_f32_16x16x32_bf16 v[92:95], v[124:127], v[28:31], v[92:95]
  s_waitcnt lgkmcnt(4)
  v_min_u32 v10, v10, v11
  v_min3_u32 v10, v10, v12, v13
  s_nop 0
  v_readfirstlane_b32 s22, v10
  s_nop 0
  s_cmp_ge_u32 s22, 4
  s_cbranch_scc1 hc_r23
hc_sp24:
  ds_read_b128 v[10:13], v2 offset:80
  s_waitcnt lgkmcnt(0)
  v_min_u32 v10, v10, v11
  v_min3_u32 v10, v10, v12, v13
  s_nop 0
  v_readfirstlane_b32 s22, v10
  s_nop 0
  s_cmp_ge_u32 s22, 4
  s_cbranch_scc1 hc_sp24d
  s_sub_u32 s99, s99, 1
  s_cbranch_scc0 hc_sp24
  s_branch L_exit
hc_sp24d:
hc_r23:
  v_mfma_f32_16x16x32_bf16 v[64:67], v[128:131], v[32:35], v[64:67]
  ds_read_b128 v[16:19], v6 offset:0
  v_mfma_f32_16x16x32_bf16 v[68:71], v[128:131], v[36:39], v[68:71]
  ds_read_b128 v[20:23], v6 offset:2048
  v_mfma_f32_16x16x32_bf16 v[72:75], v[128:131], v[40:43], v[72:75]
  ds_read_b128 v[24:27], v6 offset:4096
  v_mfma_f32_16x16x32_bf16 v[76:79], v[128:131], v[44:47], v[76:79]
  ds_read_b128 v[28:31], v6 offset:6144
  v_mfma_f32_16x16x32_bf16 v[80:83], v[132:135], v[32:35], v[80:83]
  v_mfma_f32_16x16x32_bf16 v[84:87], v[132:135], v[36:39], v[84:87]
  v_mfma_f32_16x16x32_bf16 v[88:91], v[132:135], v[40:43], v[88:91]
  v_mfma_f32_16x16x32_bf16 v[92:95], v[132:135], v[44:47], v[92:95]
  s_waitcnt lgkmcnt(4)
  v_mfma_f32_16x16x32_bf16 v[64:67], v[136:139], v[48:51], v[64:67]
  ds_read_b128 v[10:13], v2 offset:80
  v_mfma_f32_16x16x32_bf16 v[68:71], v[136:139], v[52:55], v[68:71]
  ds_read_b128 v[32:35], v7 offset:0
  v_mfma_f32_16x16x32_bf16 v[72:75], v[136:139], v[56:59], v[72:75]
  ds_read_b128 v[36:39], v7 offset:2048
  v_mfma_f32_16x16x32_bf16 v[76:79], v[136:139], v[60:63], v[76:79]
  ds_read_b128 v[40:43], v7 offset:4096
  v_mfma_f32_16x16x32_bf16 v[80:83], v[140:143], v[48:51], v[80:83]
  ds_read_b128 v[44:47], v7 offset:6144
  v_mfma_f32_16x16x32_bf16 v[84:87], v[140:143], v[52:55], v[84:87]
  v_mfma_f32_16x16x32_bf16 v[88:91], v[140:143], v[56:59], v[88:91]
  v_mfma_f32_16x16x32_bf16 v[92:95], v[140:143], v[60:63], v[92:95]
  s_waitcnt lgkmcnt(4)
  v_min_u32 v10, v10, v11
  v_min3_u32 v10, v10, v12, v13
  s_nop 0
  v_readfirstlane_b32 s22, v10
  s_nop 0
  s_cmp_ge_u32 s22, 5
  s_cbranch_scc1 hc_r25
hc_sp26:
  ds_read_b128 v[10:13], v2 offset:80
  s_waitcnt lgkmcnt(0)
  v_min_u32 v10, v10, v11
  v_min3_u32 v10, v10, v12, v13
  s_nop 0
  v_readfirstlane_b32 s22, v10
  s_nop 0
  s_cmp_ge_u32 s22, 5
  s_cbranch_scc1 hc_sp26d
  s_sub_u32 s99, s99, 1
  s_cbranch_scc0 hc_sp26
  s_branch L_exit
hc_sp26d:
hc_r25:
  v_mfma_f32_16x16x32_bf16 v[64:67], v[144:147], v[16:19], v[64:67]
  ds_read_b128 v[48:51], v6 offset:16384
  v_mfma_f32_16x16x32_bf16 v[68:71], v[144:147], v[20:23], v[68:71]
  ds_read_b128 v[52:55], v6 offset:18432
  v_mfma_f32_16x16x32_bf16 v[72:75], v[144:147], v[24:27], v[72:75]
  ds_read_b128 v[56:59], v6 offset:20480
  v_mfma_f32_16x16x32_bf16 v[76:79], v[144:147], v[28:31], v[76:79]
  ds_read_b128 v[60:63], v6 offset:22528
  v_mfma_f32_16x16x32_bf16 v[80:83], v[148:151], v[16:19], v[80:83]
  v_mfma_f32_16x16x32_bf16 v[84:87], v[148:151], v[20:23], v[84:87]
  v_mfma_f32_16x16x32_bf16 v[88:91], v[148:151], v[24:27], v[88:91]
  v_mfma_f32_16x16x32_bf16 v[92:95], v[148:151], v[28:31], v[92:95]
  s_waitcnt lgkmcnt(4)
  v_mfma_f32_16x16x32_bf16 v[64:67], v[152:155], v[32:35], v[64:67]
  ds_read_b128 v[10:13], v2 offset:80
  v_mfma_f32_16x16x32_bf16 v[68:71], v[152:155], v[36:39], v[68:71]
  ds_read_b128 v[16:19], v7 offset:16384
  v_mfma_f32_16x16x32_bf16 v[72:75], v[152:155], v[40:43], v[72:75]
  ds_read_b128 v[20:23], v7 offset:18432
  v_mfma_f32_16x16x32_bf16 v[76:79], v[152:155], v[44:47], v[76:79]
  ds_read_b128 v[24:27], v7 offset:20480
  v_mfma_f32_16x16x32_bf16 v[80:83], v[156:159], v[32:35], v[80:83]
  ds_read_b128 v[28:31], v7 offset:22528
  v_mfma_f32_16x16x32_bf16 v[84:87], v[156:159], v[36:39], v[84:87]
  v_mfma_f32_16x16x32_bf16 v[88:91], v[156:159], v[40:43], v[88:91]
  v_mfma_f32_16x16x32_bf16 v[92:95], v[156:159], v[44:47], v[92:95]
  s_waitcnt lgkmcnt(4)
  v_min_u32 v10, v10, v11
  v_min3_u32 v10, v10, v12, v13
  s_nop 0
  v_readfirstlane_b32 s22, v10
  s_nop 0
  s_cmp_ge_u32 s22, 6
  s_cbranch_scc1 hc_r27
hc_sp28:
  ds_read_b128 v[10:13], v2 offset:80
  s_waitcnt lgkmcnt(0)
  v_min_u32 v10, v10, v11
  v_min3_u32 v10, v10, v12, v13
  s_nop 0
  v_readfirstlane_b32 s22, v10
  s_nop 0
  s_cmp_ge_u32 s22, 6
  s_cbranch_scc1 hc_sp28d
  s_sub_u32 s99, s99, 1
  s_cbranch_scc0 hc_sp28
  s_branch L_exit
hc_sp28d:
hc_r27:
  v_mfma_f32_16x16x32_bf16 v[64:67], v[160:163], v[48:51], v[64:67]
  ds_read_b128 v[32:35], v6 offset:32768
  v_mfma_f32_16x16x32_bf16 v[68:71], v[160:163], v[52:55], v[68:71]
  ds_read_b128 v[36:39], v6 offset:34816
  v_mfma_f32_16x16x32_bf16 v[72:75], v[160:163], v[56:59], v[72:75]
  ds_read_b128 v[40:43], v6 offset:36864
  v_mfma_f32_16x16x32_bf16 v[76:79], v[160:163], v[60:63], v[76:79]
  ds_read_b128 v[44:47], v6 offset:38912
  v_mfma_f32_16x16x32_bf16 v[80:83], v[164:167], v[48:51], v[80:83]
  v_mfma_f32_16x16x32_bf16 v[84:87], v[164:167], v[52:55], v[84:87]
  v_mfma_f32_16x16x32_bf16 v[88:91], v[164:167], v[56:59], v[88:91]
  v_mfma_f32_16x16x32_bf16 v[92:95], v[164:167], v[60:63], v[92:95]
  s_waitcnt lgkmcnt(4)
  v_mfma_f32_16x16x32_bf16 v[64:67], v[168:171], v[16:19], v[64:67]
  ds_read_b128 v[10:13], v2 offset:80
  v_mfma_f32_16x16x32_bf16 v[68:71], v[168:171], v[20:23], v[68:71]
  ds_read_b128 v[48:51], v7 offset:32768
  v_mfma_f32_16x16x32_bf16 v[72:75], v[168:171], v[24:27], v[72:75]
  ds_read_b128 v[52:55], v7 offset:34816
  v_mfma_f32_16x16x32_bf16 v[76:79], v[168:171], v[28:31], v[76:79]
  ds_read_b128 v[56:59], v7 offset:36864
  v_mfma_f32_16x16x32_bf16 v[80:83], v[172:175], v[16:19], v[80:83]
  ds_read_b128 v[60:63], v7 offset:38912
  v_mfma_f32_16x16x32_bf16 v[84:87], v[172:175], v[20:23], v[84:87]
  v_mfma_f32_16x16x32_bf16 v[88:91], v[172:175], v[24:27], v[88:91]
  v_mfma_f32_16x16x32_bf16 v[92:95], v[172:175], v[28:31], v[92:95]
  s_waitcnt lgkmcnt(4)
  v_min_u32 v10, v10, v11
  v_min3_u32 v10, v10, v12, v13
  s_nop 0
  v_readfirstlane_b32 s22, v10
  s_nop 0
  s_cmp_ge_u32 s22, 7
  s_cbranch_scc1 hc_r29
hc_sp30:
  ds_read_b128 v[10:13], v2 offset:80
  s_waitcnt lgkmcnt(0)
  v_min_u32 v10, v10, v11
  v_min3_u32 v10, v10, v12, v13
  s_nop 0
  v_readfirstlane_b32 s22, v10
  s_nop 0
  s_cmp_ge_u32 s22, 7
  s_cbranch_scc1 hc_sp30d
  s_sub_u32 s99, s99, 1
  s_cbranch_scc0 hc_sp30
  s_branch L_exit
hc_sp30d:
hc_r29:
  v_mfma_f32_16x16x32_bf16 v[64:67], v[176:179], v[32:35], v[64:67]
  ds_read_b128 v[16:19], v8 offset:0
  v_mfma_f32_16x16x32_bf16 v[68:71], v[176:179], v[36:39], v[68:71]
  ds_read_b128 v[20:23], v8 offset:2048
  v_mfma_f32_16x16x32_bf16 v[72:75], v[176:179], v[40:43], v[72:75]
  ds_read_b128 v[24:27], v8 offset:4096
  v_mfma_f32_16x16x32_bf16 v[76:79], v[176:179], v[44:47], v[76:79]
  ds_read_b128 v[28:31], v8 offset:6144
  v_mfma_f32_16x16x32_bf16 v[80:83], v[180:183], v[32:35], v[80:83]
  v_mfma_f32_16x16x32_bf16 v[84:87], v[180:183], v[36:39], v[84:87]
  v_mfma_f32_16x16x32_bf16 v[88:91], v[180:183], v[40:43], v[88:91]
  v_mfma_f32_16x16x32_bf16 v[92:95], v[180:183], v[44:47], v[92:95]
  s_waitcnt lgkmcnt(4)
  v_mfma_f32_16x16x32_bf16 v[64:67], v[184:187], v[48:51], v[64:67]
  ds_read_b128 v[10:13], v2 offset:80
  v_mfma_f32_16x16x32_bf16 v[68:71], v[184:187], v[52:55], v[68:71]
  ds_read_b128 v[32:35], v9 offset:0
  v_mfma_f32_16x16x32_bf16 v[72:75], v[184:187], v[56:59], v[72:75]
  ds_read_b128 v[36:39], v9 offset:2048
  v_mfma_f32_16x16x32_bf16 v[76:79], v[184:187], v[60:63], v[76:79]
  ds_read_b128 v[40:43], v9 offset:4096
  v_mfma_f32_16x16x32_bf16 v[80:83], v[188:191], v[48:51], v[80:83]
  ds_read_b128 v[44:47], v9 offset:6144
  v_mfma_f32_16x16x32_bf16 v[84:87], v[188:191], v[52:55], v[84:87]
  v_mfma_f32_16x16x32_bf16 v[88:91], v[188:191], v[56:59], v[88:91]
  v_mfma_f32_16x16x32_bf16 v[92:95], v[188:191], v[60:63], v[92:95]
  s_waitcnt lgkmcnt(4)
  v_min_u32 v10, v10, v11
  v_min3_u32 v10, v10, v12, v13
  s_nop 0
  v_readfirstlane_b32 s22, v10
  s_nop 0
  s_cmp_ge_u32 s22, 8
  s_cbranch_scc1 hc_r31
hc_sp32:
  ds_read_b128 v[10:13], v2 offset:80
  s_waitcnt lgkmcnt(0)
  v_min_u32 v10, v10, v11
  v_min3_u32 v10, v10, v12, v13
  s_nop 0
  v_readfirstlane_b32 s22, v10
  s_nop 0
  s_cmp_ge_u32 s22, 8
  s_cbranch_scc1 hc_sp32d
  s_sub_u32 s99, s99, 1
  s_cbranch_scc0 hc_sp32
  s_branch L_exit
hc_sp32d:
hc_r31:
  v_mfma_f32_16x16x32_bf16 v[64:67], v[192:195], v[16:19], v[64:67]
  ds_read_b128 v[48:51], v8 offset:16384
  v_mfma_f32_16x16x32_bf16 v[68:71], v[192:195], v[20:23], v[68:71]
  ds_read_b128 v[52:55], v8 offset:18432
  v_mfma_f32_16x16x32_bf16 v[72:75], v[192:195], v[24:27], v[72:75]
  ds_read_b128 v[56:59], v8 offset:20480
  v_mfma_f32_16x16x32_bf16 v[76:79], v[192:195], v[28:31], v[76:79]
  ds_read_b128 v[60:63], v8 offset:22528
  v_mfma_f32_16x16x32_bf16 v[80:83], v[196:199], v[16:19], v[80:83]
  v_mfma_f32_16x16x32_bf16 v[84:87], v[196:199], v[20:23], v[84:87]
  v_mfma_f32_16x16x32_bf16 v[88:91], v[196:199], v[24:27], v[88:91]
  v_mfma_f32_16x16x32_bf16 v[92:95], v[196:199], v[28:31], v[92:95]
  s_waitcnt lgkmcnt(4)
  v_mfma_f32_16x16x32_bf16 v[64:67], v[200:203], v[32:35], v[64:67]
  ds_read_b128 v[10:13], v2 offset:80
  v_mfma_f32_16x16x32_bf16 v[68:71], v[200:203], v[36:39], v[68:71]
  ds_read_b128 v[16:19], v9 offset:16384
  v_mfma_f32_16x16x32_bf16 v[72:75], v[200:203], v[40:43], v[72:75]
  ds_read_b128 v[20:23], v9 offset:18432
  v_mfma_f32_16x16x32_bf16 v[76:79], v[200:203], v[44:47], v[76:79]
  ds_read_b128 v[24:27], v9 offset:20480
  v_mfma_f32_16x16x32_bf16 v[80:83], v[204:207], v[32:35], v[80:83]
  ds_read_b128 v[28:31], v9 offset:22528
  v_mfma_f32_16x16x32_bf16 v[84:87], v[204:207], v[36:39], v[84:87]
  v_mfma_f32_16x16x32_bf16 v[88:91], v[204:207], v[40:43], v[88:91]
  v_mfma_f32_16x16x32_bf16 v[92:95], v[204:207], v[44:47], v[92:95]
  s_waitcnt lgkmcnt(4)
  v_min_u32 v10, v10, v11
  v_min3_u32 v10, v10, v12, v13
  s_nop 0
  v_readfirstlane_b32 s22, v10
  s_nop 0
  s_cmp_ge_u32 s22, 9
  s_cbranch_scc1 hc_r33
hc_sp34:
  ds_read_b128 v[10:13], v2 offset:80
  s_waitcnt lgkmcnt(0)
  v_min_u32 v10, v10, v11
  v_min3_u32 v10, v10, v12, v13
  s_nop 0
  v_readfirstlane_b32 s22, v10
  s_nop 0
  s_cmp_ge_u32 s22, 9
  s_cbranch_scc1 hc_sp34d
  s_sub_u32 s99, s99, 1
  s_cbranch_scc0 hc_sp34
  s_branch L_exit
hc_sp34d:
hc_r33:
  v_mfma_f32_16x16x32_bf16 v[64:67], v[208:211], v[48:51], v[64:67]
  ds_read_b128 v[32:35], v4 offset:0
  v_mfma_f32_16x16x32_bf16 v[68:71], v[208:211], v[52:55], v[68:71]
  ds_read_b128 v[36:39], v4 offset:2048
  v_mfma_f32_16x16x32_bf16 v[72:75], v[208:211], v[56:59], v[72:75]
  ds_read_b128 v[40:43], v4 offset:4096
  v_mfma_f32_16x16x32_bf16 v[76:79], v[208:211], v[60:63], v[76:79]
  ds_read_b128 v[44:47], v4 offset:6144
  v_mfma_f32_16x16x32_bf16 v[80:83], v[212:215], v[48:51], v[80:83]
  v_mfma_f32_16x16x32_bf16 v[84:87], v[212:215], v[52:55], v[84:87]
  v_mfma_f32_16x16x32_bf16 v[88:91], v[212:215], v[56:59], v[88:91]
  v_mfma_f32_16x16x32_bf16 v[92:95], v[212:215], v[60:63], v[92:95]
  s_waitcnt lgkmcnt(4)
  v_mfma_f32_16x16x32_bf16 v[64:67], v[216:219], v[16:19], v[64:67]
  ds_read_b128 v[10:13], v2 offset:80
  v_mfma_f32_16x16x32_bf16 v[68:71], v[216:219], v[20:23], v[68:71]
  ds_read_b128 v[48:51], v5 offset:0
  v_mfma_f32_16x16x32_bf16 v[72:75], v[216:219], v[24:27], v[72:75]
  ds_read_b128 v[52:55], v5 offset:2048
  v_mfma_f32_16x16x32_bf16 v[76:79], v[216:219], v[28:31], v[76:79]
  ds_read_b128 v[56:59], v5 offset:4096
  v_mfma_f32_16x16x32_bf16 v[80:83], v[220:223], v[16:19], v[80:83]
  ds_read_b128 v[60:63], v5 offset:6144
  v_mfma_f32_16x16x32_bf16 v[84:87], v[220:223], v[20:23], v[84:87]
  v_mfma_f32_16x16x32_bf16 v[88:91], v[220:223], v[24:27], v[88:91]
  v_mfma_f32_16x16x32_bf16 v[92:95], v[220:223], v[28:31], v[92:95]
  s_waitcnt lgkmcnt(4)
  v_min_u32 v10, v10, v11
  v_min3_u32 v10, v10, v12, v13
  s_nop 0
  v_readfirstlane_b32 s22, v10
  s_nop 0
  s_cmp_ge_u32 s22, 10
  s_cbranch_scc1 hc_r35
hc_sp36:
  ds_read_b128 v[10:13], v2 offset:80
  s_waitcnt lgkmcnt(0)
  v_min_u32 v10, v10, v11
  v_min3_u32 v10, v10, v12, v13
  s_nop 0
  v_readfirstlane_b32 s22, v10
  s_nop 0
  s_cmp_ge_u32 s22, 10
  s_cbranch_scc1 hc_sp36d
  s_sub_u32 s99, s99, 1
  s_cbranch_scc0 hc_sp36
  s_branch L_exit
hc_sp36d:
hc_r35:
  v_mfma_f32_16x16x32_bf16 v[64:67], v[224:227], v[32:35], v[64:67]
  ds_read_b128 v[16:19], v4 offset:16384
  v_mfma_f32_16x16x32_bf16 v[68:71], v[224:227], v[36:39], v[68:71]
  ds_read_b128 v[20:23], v4 offset:18432
  v_mfma_f32_16x16x32_bf16 v[72:75], v[224:227], v[40:43], v[72:75]
  ds_read_b128 v[24:27], v4 offset:20480
  v_mfma_f32_16x16x32_bf16 v[76:79], v[224:227], v[44:47], v[76:79]
  ds_read_b128 v[28:31], v4 offset:22528
  v_mfma_f32_16x16x32_bf16 v[80:83], v[228:231], v[32:35], v[80:83]
  v_mfma_f32_16x16x32_bf16 v[84:87], v[228:231], v[36:39], v[84:87]
  v_mfma_f32_16x16x32_bf16 v[88:91], v[228:231], v[40:43], v[88:91]
  v_mfma_f32_16x16x32_bf16 v[92:95], v[228:231], v[44:47], v[92:95]
  s_waitcnt lgkmcnt(4)
  v_mfma_f32_16x16x32_bf16 v[64:67], v[232:235], v[48:51], v[64:67]
  ds_read_b128 v[32:35], v5 offset:16384
  v_mfma_f32_16x16x32_bf16 v[68:71], v[232:235], v[52:55], v[68:71]
  ds_read_b128 v[36:39], v5 offset:18432
  v_mfma_f32_16x16x32_bf16 v[72:75], v[232:235], v[56:59], v[72:75]
  ds_read_b128 v[40:43], v5 offset:20480
  v_mfma_f32_16x16x32_bf16 v[76:79], v[232:235], v[60:63], v[76:79]
  ds_read_b128 v[44:47], v5 offset:22528
  v_mfma_f32_16x16x32_bf16 v[80:83], v[236:239], v[48:51], v[80:83]
  v_mfma_f32_16x16x32_bf16 v[84:87], v[236:239], v[52:55], v[84:87]
  v_mfma_f32_16x16x32_bf16 v[88:91], v[236:239], v[56:59], v[88:91]
  v_mfma_f32_16x16x32_bf16 v[92:95], v[236:239], v[60:63], v[92:95]
  s_waitcnt lgkmcnt(4)
  v_mfma_f32_16x16x32_bf16 v[64:67], v[240:243], v[16:19], v[64:67]
  v_mfma_f32_16x16x32_bf16 v[68:71], v[240:243], v[20:23], v[68:71]
  v_mfma_f32_16x16x32_bf16 v[72:75], v[240:243], v[24:27], v[72:75]
  v_mfma_f32_16x16x32_bf16 v[76:79], v[240:243], v[28:31], v[76:79]
  v_mfma_f32_16x16x32_bf16 v[80:83], v[244:247], v[16:19], v[80:83]
  v_mfma_f32_16x16x32_bf16 v[84:87], v[244:247], v[20:23], v[84:87]
  v_mfma_f32_16x16x32_bf16 v[88:91], v[244:247], v[24:27], v[88:91]
  v_mfma_f32_16x16x32_bf16 v[92:95], v[244:247], v[28:31], v[92:95]
  s_waitcnt lgkmcnt(0)
  v_mfma_f32_16x16x32_bf16 v[64:67], v[248:251], v[32:35], v[64:67]
  v_mfma_f32_16x16x32_bf16 v[68:71], v[248:251], v[36:39], v[68:71]
  v_mfma_f32_16x16x32_bf16 v[72:75], v[248:251], v[40:43], v[72:75]
  v_mfma_f32_16x16x32_bf16 v[76:79], v[248:251], v[44:47], v[76:79]
  v_mfma_f32_16x16x32_bf16 v[80:83], v[252:255], v[32:35], v[80:83]
  v_mfma_f32_16x16x32_bf16 v[84:87], v[252:255], v[36:39], v[84:87]
  v_mfma_f32_16x16x32_bf16 v[88:91], v[252:255], v[40:43], v[88:91]
  v_mfma_f32_16x16x32_bf16 v[92:95], v[252:255], v[44:47], v[92:95]
  v_and_b32 v10, 15, v1
  v_lshrrev_b32 v11, 4, v1
  v_mul_u32_u24 v12, 144, v10
  v_lshl_add_u32 v12, v11, 3, v12
  s_lshr_b32 s22, s33, 1
  s_mul_i32 s22, s22, 9216
  s_and_b32 s23, s33, 1
  s_lshl_b32 s23, s23, 6
  s_add_u32 s22, s22, s23
  s_add_u32 s22, s22, 131072
  v_add_u32 v12, s22, v12
  s_nop 4
  v_cvt_pk_bf16_f32 v64, v64, v65
  v_cvt_pk_bf16_f32 v65, v66, v67
  ds_write_b64 v12, v[64:65] offset:0
  v_cvt_pk_bf16_f32 v68, v68, v69
  v_cvt_pk_bf16_f32 v69, v70, v71
  ds_write_b64 v12, v[68:69] offset:2304
  v_cvt_pk_bf16_f32 v72, v72, v73
  v_cvt_pk_bf16_f32 v73, v74, v75
  ds_write_b64 v12, v[72:73] offset:4608
  v_cvt_pk_bf16_f32 v76, v76, v77
  v_cvt_pk_bf16_f32 v77, v78, v79
  ds_write_b64 v12, v[76:77] offset:6912
  v_cvt_pk_bf16_f32 v80, v80, v81
  v_cvt_pk_bf16_f32 v81, v82, v83
  ds_write_b64 v12, v[80:81] offset:32
  v_cvt_pk_bf16_f32 v84, v84, v85
  v_cvt_pk_bf16_f32 v85, v86, v87
  ds_write_b64 v12, v[84:85] offset:2336
  v_cvt_pk_bf16_f32 v88, v88, v89
  v_cvt_pk_bf16_f32 v89, v90, v91
  ds_write_b64 v12, v[88:89] offset:4640
  v_cvt_pk_bf16_f32 v92, v92, v93
  v_cvt_pk_bf16_f32 v93, v94, v95
  ds_write_b64 v12, v[92:93] offset:6944
  s_waitcnt lgkmcnt(0)
  s_mov_b64 exec, 1
  ds_add_u32 v2, v3 offset:48
  s_mov_b64 exec, -1
  v_lshrrev_b32 v10, 3, v1
  s_lshl_b32 s22, s33, 5
  v_add_u32 v10, s22, v10
  v_and_b32 v11, 7, v1
  v_mul_u32_u24 v12, 144, v10
  v_lshl_add_u32 v12, v11, 4, v12
  v_add_u32 v12, 131072, v12
  s_lshl_b32 s22, s20, 7
  v_add_u32 v10, s22, v10
  v_mul_u32_u24 v10, 2560, v10
  v_lshl_add_u32 v10, v11, 4, v10
  s_lshl_b32 s23, s21, 7
  s_add_u32 s23, s23, 1280
hc_sp37:
  ds_read_b32 v14, v2 offset:48
  s_waitcnt lgkmcnt(0)
  v_readfirstlane_b32 s22, v14
  s_nop 0
  s_cmp_ge_u32 s22, 4
  s_cbranch_scc1 hc_sp37d
  s_sub_u32 s99, s99, 1
  s_cbranch_scc0 hc_sp37
  s_branch L_exit
hc_sp37d:
  ds_read_b128 v[16:19], v12 offset:0
  ds_read_b128 v[20:23], v12 offset:1152
  ds_read_b128 v[24:27], v12 offset:2304
  ds_read_b128 v[28:31], v12 offset:3456
  s_waitcnt lgkmcnt(3)
  buffer_store_dwordx4 v[16:19], v10, s[8:11], s23 offen sc1 nt
  s_add_u32 s23, s23, 20480
  s_waitcnt lgkmcnt(2)
  buffer_store_dwordx4 v[20:23], v10, s[8:11], s23 offen sc1 nt
  s_add_u32 s23, s23, 20480
  s_waitcnt lgkmcnt(1)
  buffer_store_dwordx4 v[24:27], v10, s[8:11], s23 offen sc1 nt
  s_add_u32 s23, s23, 20480
  s_waitcnt lgkmcnt(0)
  buffer_store_dwordx4 v[28:31], v10, s[8:11], s23 offen sc1 nt
  s_branch L_exit
L_A:
  s_sub_u32 s98, s2, 176
  s_cmp_eq_u32 s33, 7
  s_cbranch_scc0 L_anz
  v_mov_b32 v2, 0
  v_lshlrev_b32 v3, 2, v1
  v_add_u32 v3, 163584, v3
  ds_write_b32 v3, v2
L_anz:
  s_cmp_lt_u32 s98, 8
  s_cbranch_scc0 L_ncpf
  s_getpc_b64 s[52:53]
L_pc0:
  s_sub_u32 s52, s52, L_pc0 - mega_kernel
  s_subb_u32 s53, s53, 0
  s_lshl_b32 s54, s33, 12
  v_lshlrev_b32 v248, 4, v1
  v_add_u32 v248, s54, v248
  v_min_u32 v248, L_code_end - mega_kernel - 3088, v248
  global_load_dwordx4 v[252:255], v248, s[52:53] offset:0
  global_load_dwordx4 v[252:255], v248, s[52:53] offset:1024
  global_load_dwordx4 v[252:255], v248, s[52:53] offset:2048
  global_load_dwordx4 v[252:255], v248, s[52:53] offset:3072
L_ncpf:
  s_load_dwordx2 s[52:53], s[0:1], 80
  s_waitcnt lgkmcnt(0)
  s_and_b32 s34, s33, 3
  s_lshr_b32 s35, s33, 2
  s_mul_i32 s27, s98, 205
  s_lshr_b32 s27, s27, 11
  s_mul_i32 s22, s27, 10
  s_sub_u32 s26, s98, s22
  s_lshl_b32 s28, s27, 1
  s_add_u32 s28, s28, s35
  s_lshl_b32 s28, s28, 7
  s_mul_i32 s29, s35, 33792
  s_lshl_b32 s30, s26, 6
  s_lshl_b32 s22, s27, 3
  s_add_u32 s22, s22, s33
  s_add_u32 s30, s30, s22
  s_lshl_b32 s63, s26, 8
  s_lshl_b32 s50, s22, 2
  s_add_u32 s50, s50, s63
  s_mul_i32 s31, s33, 8448
  s_add_u32 s31, s31, 81920
  s_waitcnt lgkmcnt(0)
  s_add_u32 s38, s48, 0xa00000
  s_addc_u32 s39, s49, 0
  s_and_b32 s20, s2, 3
  s_mul_i32 s20, s20, 22
  s_lshr_b32 s20, s20, 2
  s_mul_i32 s20, s20, 96
  s_sub_u32 s20, s20, 16
  s_max_i32 s20, s20, 0
  s_mul_i32 s20, s20, 1280
  s_lshr_b32 s21, s98, 3
  s_lshl_b32 s21, s21, 3
  s_add_u32 s21, s21, s33
  s_lshl_b32 s21, s21, 10
  s_add_u32 s20, s20, s21
  v_lshlrev_b32 v240, 4, v1
  s_mov_b32 s56, s40
  s_and_b32 s57, s41, 0xffff
  s_mov_b32 s58, 2621440
  s_mov_b32 s59, 0x20000
  buffer_load_dwordx4 v[244:247], v240, s[56:59], s20 offen
  s_add_u32 s20, s20, 81920
  buffer_load_dwordx4 v[244:247], v240, s[56:59], s20 offen
  s_add_u32 s20, s20, 81920
  buffer_load_dwordx4 v[244:247], v240, s[56:59], s20 offen
  s_add_u32 s20, s20, 81920
  buffer_load_dwordx4 v[244:247], v240, s[56:59], s20 offen
  s_add_u32 s20, s20, 81920
  buffer_load_dwordx4 v[244:247], v240, s[56:59], s20 offen
  s_add_u32 s20, s20, 81920
  buffer_load_dwordx4 v[244:247], v240, s[56:59], s20 offen
  s_add_u32 s20, s20, 81920
  buffer_load_dwordx4 v[244:247], v240, s[56:59], s20 offen
  s_add_u32 s20, s20, 81920
  buffer_load_dwordx4 v[244:247], v240, s[56:59], s20 offen
  s_add_u32 s20, s20, 81920
  buffer_load_dwordx4 v[244:247], v240, s[56:59], s20 offen
  s_add_u32 s20, s20, 81920
  s_lshr_b32 s21, s98, 3
  s_lshl_b32 s21, s21, 3
  s_add_u32 s21, s21, s33
  s_mul_i32 s21, s21, 40
  v_lshrrev_b32 v232, 3, v1
  v_add_u32 v232, s21, v232
  s_and_b32 s22, s2, 4
  s_mul_i32 s22, s22, 160
  s_mov_b32 s56, s42
  s_and_b32 s57, s43, 0xffff
  s_mov_b32 s58, 2457600
  s_mov_b32 s59, 0x20000
  v_and_b32 v233, 7, v1
  v_lshlrev_b32 v233, 4, v233
  v_add_u32 v233, s22, v233
  v_mul_u32_u24 v234, 21846, v232
  v_lshrrev_b32 v234, 22, v234
  v_mul_u32_u24 v235, 192, v234
  v_sub_u32 v235, v232, v235
  v_mul_u32_u24 v236, 86, v235
  v_lshrrev_b32 v236, 8, v236
  v_mul_u32_u24 v237, 3, v236
  v_sub_u32 v237, v235, v237
  v_lshl_add_u32 v236, v234, 7, v236
  v_mul_u32_u24 v236, 3840, v236
  v_mul_u32_u24 v237, 1280, v237
  v_add3_u32 v238, v236, v237, v233
  v_add_u32 v238, 256, v238
  v_subrev_u32 v234, 960, v232
  v_mul_u32_u24 v235, 10923, v234
  v_lshrrev_b32 v235, 22, v235
  v_mul_u32_u24 v236, 384, v235
  v_sub_u32 v236, v234, v236
  v_mul_u32_u24 v237, 171, v236
  v_lshrrev_b32 v237, 10, v237
  v_mul_u32_u24 v239, 6, v237
  v_sub_u32 v239, v236, v239
  v_lshl_add_u32 v237, v235, 7, v237
  v_add_u32 v237, 64, v237
  v_mul_u32_u24 v237, 3840, v237
  v_lshrrev_b32 v240, 1, v239
  v_mul_u32_u24 v240, 1280, v240
  v_and_b32 v239, 1, v239
  v_lshlrev_b32 v239, 9, v239
  v_add3_u32 v237, v237, v240, v239
  v_add_u32 v237, v237, v233
  v_cmp_gt_u32 vcc, 960, v232
  s_nop 1
  v_cndmask_b32 v238, v237, v238, vcc
  v_cmp_gt_u32 vcc, 2880, v232
  v_mov_b32 v239, 0x80000000
  s_nop 0
  v_cndmask_b32 v238, v239, v238, vcc
  buffer_load_dwordx4 v[244:247], v238, s[56:59], 0 offen
  v_add_u32 v232, 8, v232
  v_mul_u32_u24 v234, 21846, v232
  v_lshrrev_b32 v234, 22, v234
  v_mul_u32_u24 v235, 192, v234
  v_sub_u32 v235, v232, v235
  v_mul_u32_u24 v236, 86, v235
  v_lshrrev_b32 v236, 8, v236
  v_mul_u32_u24 v237, 3, v236
  v_sub_u32 v237, v235, v237
  v_lshl_add_u32 v236, v234, 7, v236
  v_mul_u32_u24 v236, 3840, v236
  v_mul_u32_u24 v237, 1280, v237
  v_add3_u32 v238, v236, v237, v233
  v_add_u32 v238, 256, v238
  v_subrev_u32 v234, 960, v232
  v_mul_u32_u24 v235, 10923, v234
  v_lshrrev_b32 v235, 22, v235
  v_mul_u32_u24 v236, 384, v235
  v_sub_u32 v236, v234, v236
  v_mul_u32_u24 v237, 171, v236
  v_lshrrev_b32 v237, 10, v237
  v_mul_u32_u24 v239, 6, v237
  v_sub_u32 v239, v236, v239
  v_lshl_add_u32 v237, v235, 7, v237
  v_add_u32 v237, 64, v237
  v_mul_u32_u24 v237, 3840, v237
  v_lshrrev_b32 v240, 1, v239
  v_mul_u32_u24 v240, 1280, v240
  v_and_b32 v239, 1, v239
  v_lshlrev_b32 v239, 9, v239
  v_add3_u32 v237, v237, v240, v239
  v_add_u32 v237, v237, v233
  v_cmp_gt_u32 vcc, 960, v232
  s_nop 1
  v_cndmask_b32 v238, v237, v238, vcc
  v_cmp_gt_u32 vcc, 2880, v232
  v_mov_b32 v239, 0x80000000
  s_nop 0
  v_cndmask_b32 v238, v239, v238, vcc
  buffer_load_dwordx4 v[244:247], v238, s[56:59], 0 offen
  v_add_u32 v232, 8, v232
  v_mul_u32_u24 v234, 21846, v232
  v_lshrrev_b32 v234, 22, v234
  v_mul_u32_u24 v235, 192, v234
  v_sub_u32 v235, v232, v235
  v_mul_u32_u24 v236, 86, v235
  v_lshrrev_b32 v236, 8, v236
  v_mul_u32_u24 v237, 3, v236
  v_sub_u32 v237, v235, v237
  v_lshl_add_u32 v236, v234, 7, v236
  v_mul_u32_u24 v236, 3840, v236
  v_mul_u32_u24 v237, 1280, v237
  v_add3_u32 v238, v236, v237, v233
  v_add_u32 v238, 256, v238
  v_subrev_u32 v234, 960, v232
  v_mul_u32_u24 v235, 10923, v234
  v_lshrrev_b32 v235, 22, v235
  v_mul_u32_u24 v236, 384, v235
  v_sub_u32 v236, v234, v236
  v_mul_u32_u24 v237, 171, v236
  v_lshrrev_b32 v237, 10, v237
  v_mul_u32_u24 v239, 6, v237
  v_sub_u32 v239, v236, v239
  v_lshl_add_u32 v237, v235, 7, v237
  v_add_u32 v237, 64, v237
  v_mul_u32_u24 v237, 3840, v237
  v_lshrrev_b32 v240, 1, v239
  v_mul_u32_u24 v240, 1280, v240
  v_and_b32 v239, 1, v239
  v_lshlrev_b32 v239, 9, v239
  v_add3_u32 v237, v237, v240, v239
  v_add_u32 v237, v237, v233
  v_cmp_gt_u32 vcc, 960, v232
  s_nop 1
  v_cndmask_b32 v238, v237, v238, vcc
  v_cmp_gt_u32 vcc, 2880, v232
  v_mov_b32 v239, 0x80000000
  s_nop 0
  v_cndmask_b32 v238, v239, v238, vcc
  buffer_load_dwordx4 v[244:247], v238, s[56:59], 0 offen
  v_add_u32 v232, 8, v232
  v_mul_u32_u24 v234, 21846, v232
  v_lshrrev_b32 v234, 22, v234
  v_mul_u32_u24 v235, 192, v234
  v_sub_u32 v235, v232, v235
  v_mul_u32_u24 v236, 86, v235
  v_lshrrev_b32 v236, 8, v236
  v_mul_u32_u24 v237, 3, v236
  v_sub_u32 v237, v235, v237
  v_lshl_add_u32 v236, v234, 7, v236
  v_mul_u32_u24 v236, 3840, v236
  v_mul_u32_u24 v237, 1280, v237
  v_add3_u32 v238, v236, v237, v233
  v_add_u32 v238, 256, v238
  v_subrev_u32 v234, 960, v232
  v_mul_u32_u24 v235, 10923, v234
  v_lshrrev_b32 v235, 22, v235
  v_mul_u32_u24 v236, 384, v235
  v_sub_u32 v236, v234, v236
  v_mul_u32_u24 v237, 171, v236
  v_lshrrev_b32 v237, 10, v237
  v_mul_u32_u24 v239, 6, v237
  v_sub_u32 v239, v236, v239
  v_lshl_add_u32 v237, v235, 7, v237
  v_add_u32 v237, 64, v237
  v_mul_u32_u24 v237, 3840, v237
  v_lshrrev_b32 v240, 1, v239
  v_mul_u32_u24 v240, 1280, v240
  v_and_b32 v239, 1, v239
  v_lshlrev_b32 v239, 9, v239
  v_add3_u32 v237, v237, v240, v239
  v_add_u32 v237, v237, v233
  v_cmp_gt_u32 vcc, 960, v232
  s_nop 1
  v_cndmask_b32 v238, v237, v238, vcc
  v_cmp_gt_u32 vcc, 2880, v232
  v_mov_b32 v239, 0x80000000
  s_nop 0
  v_cndmask_b32 v238, v239, v238, vcc
  buffer_load_dwordx4 v[244:247], v238, s[56:59], 0 offen
  v_add_u32 v232, 8, v232
  v_mul_u32_u24 v234, 21846, v232
  v_lshrrev_b32 v234, 22, v234
  v_mul_u32_u24 v235, 192, v234
  v_sub_u32 v235, v232, v235
  v_mul_u32_u24 v236, 86, v235
  v_lshrrev_b32 v236, 8, v236
  v_mul_u32_u24 v237, 3, v236
  v_sub_u32 v237, v235, v237
  v_lshl_add_u32 v236, v234, 7, v236
  v_mul_u32_u24 v236, 3840, v236
  v_mul_u32_u24 v237, 1280, v237
  v_add3_u32 v238, v236, v237, v233
  v_add_u32 v238, 256, v238
  v_subrev_u32 v234, 960, v232
  v_mul_u32_u24 v235, 10923, v234
  v_lshrrev_b32 v235, 22, v235
  v_mul_u32_u24 v236, 384, v235
  v_sub_u32 v236, v234, v236
  v_mul_u32_u24 v237, 171, v236
  v_lshrrev_b32 v237, 10, v237
  v_mul_u32_u24 v239, 6, v237
  v_sub_u32 v239, v236, v239
  v_lshl_add_u32 v237, v235, 7, v237
  v_add_u32 v237, 64, v237
  v_mul_u32_u24 v237, 3840, v237
  v_lshrrev_b32 v240, 1, v239
  v_mul_u32_u24 v240, 1280, v240
  v_and_b32 v239, 1, v239
  v_lshlrev_b32 v239, 9, v239
  v_add3_u32 v237, v237, v240, v239
  v_add_u32 v237, v237, v233
  v_cmp_gt_u32 vcc, 960, v232
  s_nop 1
  v_cndmask_b32 v238, v237, v238, vcc
  v_cmp_gt_u32 vcc, 2880, v232
  v_mov_b32 v239, 0x80000000
  s_nop 0
  v_cndmask_b32 v238, v239, v238, vcc
  buffer_load_dwordx4 v[244:247], v238, s[56:59], 0 offen
  s_waitcnt vmcnt(0)
  s_load_dwordx2 s[60:61], s[0:1], 24
  v_lshrrev_b32 v4, 3, v1
  v_and_b32 v5, 7, v1
  v_and_b32 v6, 2, v4
  v_xor_b32 v5, v5, v6
  v_mul_u32_u24 v6, 1280, v4
  v_lshl_add_u32 v2, v5, 4, v6
  v_xor_b32 v3, 64, v2
  s_and_b32 s22, s34, 1
  s_cmp_eq_u32 s22, 0
  s_cselect_b64 vcc, -1, 0
  v_cndmask_b32 v2, v3, v2, vcc
  s_lshl_b32 s22, s26, 7
  s_sub_u32 s23, s28, 8
  s_lshl_b32 s24, s34, 3
  s_add_u32 s23, s23, s24
  s_mul_i32 s23, s23, 1280
  s_add_u32 s23, s23, s22
  v_add_u32 v4, s23, v2
  s_lshl_b32 s24, s34, 10
  s_add_u32 s24, s24, s29
  s_mov_b32 s8, s44
  s_and_b32 s9, s45, 0xffff
  s_mov_b32 s10, 2621440
  s_mov_b32 s11, 0x20000
  s_mov_b32 s12, s46
  s_and_b32 s13, s47, 0xffff
  s_mov_b32 s14, 2621440
  s_mov_b32 s15, 0x20000
  s_add_u32 m0, s24, 0
  s_nop 0
  buffer_load_dwordx4 v4, s[8:11], 0 offen nt lds
  s_add_u32 m0, s24, 4096
  v_add_u32 v4, 40960, v4
  buffer_load_dwordx4 v4, s[8:11], 0 offen nt lds
  s_add_u32 m0, s24, 8192
  v_add_u32 v4, 40960, v4
  buffer_load_dwordx4 v4, s[8:11], 0 offen nt lds
  s_add_u32 m0, s24, 12288
  v_add_u32 v4, 40960, v4
  buffer_load_dwordx4 v4, s[8:11], 0 offen nt lds
  s_add_u32 m0, s24, 16384
  v_add_u32 v4, 40960, v4
  s_cmp_eq_u32 s34, 0
  s_cbranch_scc0 a1_k4
  buffer_load_dwordx4 v4, s[8:11], 0 offen nt lds
a1_k4:
  s_add_u32 s23, s23, 10240
  s_add_u32 m0, s24, 17408
  s_add_u32 s22, s23, 0
  buffer_load_dwordx4 v2, s[12:15], s22 offen nt lds
  s_add_u32 m0, s24, 21504
  s_add_u32 s22, s23, 40960
  buffer_load_dwordx4 v2, s[12:15], s22 offen nt lds
  s_add_u32 m0, s24, 25600
  s_add_u32 s22, s23, 81920
  buffer_load_dwordx4 v2, s[12:15], s22 offen nt lds
  s_add_u32 m0, s24, 29696
  s_add_u32 s22, s23, 122880
  buffer_load_dwordx4 v2, s[12:15], s22 offen nt lds
  v_and_b32 v4, 15, v1
  s_lshl_b32 s22, s26, 6
  s_lshl_b32 s24, s34, 4
  s_add_u32 s22, s22, s24
  v_add_u32 v16, s22, v4
  v_lshlrev_b32 v5, 3, v16
  s_waitcnt lgkmcnt(0)
  s_mov_b32 s16, s60
  s_and_b32 s17, s61, 0xffff
  s_mov_b32 s18, 5120
  s_mov_b32 s19, 0x20000
  buffer_load_dwordx2 v[14:15], v5, s[16:19], 0 offen
  v_mov_b32 v76, 0
  global_load_dword v77, v76, s[52:53] sc1
  s_add_u32 s8, s48, 0x300000
  s_addc_u32 s9, s49, 0
  s_and_b32 s9, s9, 0xffff
  s_mov_b32 s10, 2621440
  s_mov_b32 s11, 0x20000
  v_lshrrev_b32 v20, 4, v1
  v_lshlrev_b32 v8, 12, v16
  v_lshl_add_u32 v8, v20, 4, v8
  s_lshl_b32 s22, s28, 1
  v_add_u32 v8, s22, v8
  v_bfe_u32 v21, v1, 2, 2
  v_and_b32 v22, 3, v1
  v_lshrrev_b32 v23, 1, v21
  v_and_b32 v18, 1, v20
  v_lshl_or_b32 v23, v18, 1, v23
  v_xor_b32 v23, s34, v23
  v_lshlrev_b32 v23, 5, v23
  v_lshl_add_u32 v23, v22, 3, v23
  v_lshl_add_u32 v18, v20, 3, v21
  v_lshl_add_u32 v7, v18, 7, v23
  v_xor_b32 v6, 64, v7
  v_add_u32 v5, 512, v7
  v_add_u32 v6, 1024, v6
  v_add_u32 v7, 17408, v7
  v_add_u32 v5, s29, v5
  v_add_u32 v6, s29, v6
  v_add_u32 v7, s29, v7
  v_and_b32 v17, 15, v1
  v_mul_u32_u24 v17, 272, v17
  v_lshl_add_u32 v17, v20, 4, v17
  v_add_u32 v17, s31, v17
  s_waitcnt vmcnt(1)
  s_barrier
  v_lshlrev_b32 v10, 16, v14
  v_and_b32 v11, 0xffff0000, v14
  v_lshlrev_b32 v12, 16, v15
  v_and_b32 v13, 0xffff0000, v15
  ds_read_b64_tr_b16 v[24:25], v5 offset:0
  ds_read_b64_tr_b16 v[26:27], v6 offset:0
  ds_read_b64_tr_b16 v[28:29], v6 offset:512
  ds_read_b64_tr_b16 v[42:43], v7 offset:0
  ds_read_b64_tr_b16 v[44:45], v7 offset:512
  s_waitcnt lgkmcnt(2)
  v_and_b32 v31, 0xffff0000, v24
  v_lshlrev_b32 v32, 16, v25
  v_and_b32 v33, 0xffff0000, v25
  v_lshlrev_b32 v34, 16, v26
  v_and_b32 v35, 0xffff0000, v26
  v_lshlrev_b32 v36, 16, v27
  v_and_b32 v37, 0xffff0000, v27
  v_lshlrev_b32 v38, 16, v28
  v_and_b32 v39, 0xffff0000, v28
  v_lshlrev_b32 v40, 16, v29
  v_and_b32 v41, 0xffff0000, v29
  v_mul_f32 v54, v13, v31
  v_mul_f32 v55, v13, v32
  v_mul_f32 v56, v13, v33
  v_mul_f32 v57, v13, v34
  v_mul_f32 v58, v13, v35
  v_mul_f32 v59, v13, v36
  v_mul_f32 v60, v13, v37
  v_mul_f32 v61, v13, v38
  v_fmac_f32 v54, v12, v32
  v_fmac_f32 v55, v12, v33
  v_fmac_f32 v56, v12, v34
  v_fmac_f32 v57, v12, v35
  v_fmac_f32 v58, v12, v36
  v_fmac_f32 v59, v12, v37
  v_fmac_f32 v60, v12, v38
  v_fmac_f32 v61, v12, v39
  v_fmac_f32 v54, v11, v33
  v_fmac_f32 v55, v11, v34
  v_fmac_f32 v56, v11, v35
  v_fmac_f32 v57, v11, v36
  v_fmac_f32 v58, v11, v37
  v_fmac_f32 v59, v11, v38
  v_fmac_f32 v60, v11, v39
  v_fmac_f32 v61, v11, v40
  v_fmac_f32 v54, v10, v34
  v_fmac_f32 v55, v10, v35
  v_fmac_f32 v56, v10, v36
  v_fmac_f32 v57, v10, v37
  v_fmac_f32 v58, v10, v38
  v_fmac_f32 v59, v10, v39
  v_fmac_f32 v60, v10, v40
  v_fmac_f32 v61, v10, v41
  s_waitcnt lgkmcnt(0)
  v_lshlrev_b32 v46, 16, v42
  v_and_b32 v47, 0xffff0000, v42
  v_lshlrev_b32 v48, 16, v43
  v_and_b32 v49, 0xffff0000, v43
  v_lshlrev_b32 v50, 16, v44
  v_and_b32 v51, 0xffff0000, v44
  v_lshlrev_b32 v52, 16, v45
  v_and_b32 v53, 0xffff0000, v45
  v_mul_f32 v54, v54, v46
  v_mul_f32 v55, v55, v47
  v_mul_f32 v56, v56, v48
  v_mul_f32 v57, v57, v49
  v_mul_f32 v58, v58, v50
  v_mul_f32 v59, v59, v51
  v_mul_f32 v60, v60, v52
  v_mul_f32 v61, v61, v53
  v_cvt_pk_bf16_f32 v62, v54, v55
  v_cvt_pk_bf16_f32 v63, v56, v57
  v_cvt_pk_bf16_f32 v64, v58, v59
  v_cvt_pk_bf16_f32 v65, v60, v61
  ds_write_b128 v17, v[62:65] offset:0
  ds_read_b64_tr_b16 v[24:25], v5 offset:4096
  ds_read_b64_tr_b16 v[26:27], v6 offset:4096
  ds_read_b64_tr_b16 v[28:29], v6 offset:4608
  ds_read_b64_tr_b16 v[42:43], v7 offset:4096
  ds_read_b64_tr_b16 v[44:45], v7 offset:4608
  s_waitcnt lgkmcnt(2)
  v_and_b32 v31, 0xffff0000, v24
  v_lshlrev_b32 v32, 16, v25
  v_and_b32 v33, 0xffff0000, v25
  v_lshlrev_b32 v34, 16, v26
  v_and_b32 v35, 0xffff0000, v26
  v_lshlrev_b32 v36, 16, v27
  v_and_b32 v37, 0xffff0000, v27
  v_lshlrev_b32 v38, 16, v28
  v_and_b32 v39, 0xffff0000, v28
  v_lshlrev_b32 v40, 16, v29
  v_and_b32 v41, 0xffff0000, v29
  v_mul_f32 v54, v13, v31
  v_mul_f32 v55, v13, v32
  v_mul_f32 v56, v13, v33
  v_mul_f32 v57, v13, v34
  v_mul_f32 v58, v13, v35
  v_mul_f32 v59, v13, v36
  v_mul_f32 v60, v13, v37
  v_mul_f32 v61, v13, v38
  v_fmac_f32 v54, v12, v32
  v_fmac_f32 v55, v12, v33
  v_fmac_f32 v56, v12, v34
  v_fmac_f32 v57, v12, v35
  v_fmac_f32 v58, v12, v36
  v_fmac_f32 v59, v12, v37
  v_fmac_f32 v60, v12, v38
  v_fmac_f32 v61, v12, v39
  v_fmac_f32 v54, v11, v33
  v_fmac_f32 v55, v11, v34
  v_fmac_f32 v56, v11, v35
  v_fmac_f32 v57, v11, v36
  v_fmac_f32 v58, v11, v37
  v_fmac_f32 v59, v11, v38
  v_fmac_f32 v60, v11, v39
  v_fmac_f32 v61, v11, v40
  v_fmac_f32 v54, v10, v34
  v_fmac_f32 v55, v10, v35
  v_fmac_f32 v56, v10, v36
  v_fmac_f32 v57, v10, v37
  v_fmac_f32 v58, v10, v38
  v_fmac_f32 v59, v10, v39
  v_fmac_f32 v60, v10, v40
  v_fmac_f32 v61, v10, v41
  s_waitcnt lgkmcnt(0)
  v_lshlrev_b32 v46, 16, v42
  v_and_b32 v47, 0xffff0000, v42
  v_lshlrev_b32 v48, 16, v43
  v_and_b32 v49, 0xffff0000, v43
  v_lshlrev_b32 v50, 16, v44
  v_and_b32 v51, 0xffff0000, v44
  v_lshlrev_b32 v52, 16, v45
  v_and_b32 v53, 0xffff0000, v45
  v_mul_f32 v54, v54, v46
  v_mul_f32 v55, v55, v47
  v_mul_f32 v56, v56, v48
  v_mul_f32 v57, v57, v49
  v_mul_f32 v58, v58, v50
  v_mul_f32 v59, v59, v51
  v_mul_f32 v60, v60, v52
  v_mul_f32 v61, v61, v53
  v_cvt_pk_bf16_f32 v66, v54, v55
  v_cvt_pk_bf16_f32 v67, v56, v57
  v_cvt_pk_bf16_f32 v68, v58, v59
  v_cvt_pk_bf16_f32 v69, v60, v61
  ds_write_b128 v17, v[66:69] offset:64
  ds_read_b64_tr_b16 v[24:25], v5 offset:8192
  ds_read_b64_tr_b16 v[26:27], v6 offset:8192
  ds_read_b64_tr_b16 v[28:29], v6 offset:8704
  ds_read_b64_tr_b16 v[42:43], v7 offset:8192
  ds_read_b64_tr_b16 v[44:45], v7 offset:8704
  s_waitcnt lgkmcnt(2)
  v_and_b32 v31, 0xffff0000, v24
  v_lshlrev_b32 v32, 16, v25
  v_and_b32 v33, 0xffff0000, v25
  v_lshlrev_b32 v34, 16, v26
  v_and_b32 v35, 0xffff0000, v26
  v_lshlrev_b32 v36, 16, v27
  v_and_b32 v37, 0xffff0000, v27
  v_lshlrev_b32 v38, 16, v28
  v_and_b32 v39, 0xffff0000, v28
  v_lshlrev_b32 v40, 16, v29
  v_and_b32 v41, 0xffff0000, v29
  v_mul_f32 v54, v13, v31
  v_mul_f32 v55, v13, v32
  v_mul_f32 v56, v13, v33
  v_mul_f32 v57, v13, v34
  v_mul_f32 v58, v13, v35
  v_mul_f32 v59, v13, v36
  v_mul_f32 v60, v13, v37
  v_mul_f32 v61, v13, v38
  v_fmac_f32 v54, v12, v32
  v_fmac_f32 v55, v12, v33
  v_fmac_f32 v56, v12, v34
  v_fmac_f32 v57, v12, v35
  v_fmac_f32 v58, v12, v36
  v_fmac_f32 v59, v12, v37
  v_fmac_f32 v60, v12, v38
  v_fmac_f32 v61, v12, v39
  v_fmac_f32 v54, v11, v33
  v_fmac_f32 v55, v11, v34
  v_fmac_f32 v56, v11, v35
  v_fmac_f32 v57, v11, v36
  v_fmac_f32 v58, v11, v37
  v_fmac_f32 v59, v11, v38
  v_fmac_f32 v60, v11, v39
  v_fmac_f32 v61, v11, v40
  v_fmac_f32 v54, v10, v34
  v_fmac_f32 v55, v10, v35
  v_fmac_f32 v56, v10, v36
  v_fmac_f32 v57, v10, v37
  v_fmac_f32 v58, v10, v38
  v_fmac_f32 v59, v10, v39
  v_fmac_f32 v60, v10, v40
  v_fmac_f32 v61, v10, v41
  s_waitcnt lgkmcnt(0)
  v_lshlrev_b32 v46, 16, v42
  v_and_b32 v47, 0xffff0000, v42
  v_lshlrev_b32 v48, 16, v43
  v_and_b32 v49, 0xffff0000, v43
  v_lshlrev_b32 v50, 16, v44
  v_and_b32 v51, 0xffff0000, v44
  v_lshlrev_b32 v52, 16, v45
  v_and_b32 v53, 0xffff0000, v45
  v_mul_f32 v54, v54, v46
  v_mul_f32 v55, v55, v47
  v_mul_f32 v56, v56, v48
  v_mul_f32 v57, v57, v49
  v_mul_f32 v58, v58, v50
  v_mul_f32 v59, v59, v51
  v_mul_f32 v60, v60, v52
  v_mul_f32 v61, v61, v53
  v_cvt_pk_bf16_f32 v62, v54, v55
  v_cvt_pk_bf16_f32 v63, v56, v57
  v_cvt_pk_bf16_f32 v64, v58, v59
  v_cvt_pk_bf16_f32 v65, v60, v61
  ds_write_b128 v17, v[62:65] offset:128
  ds_read_b64_tr_b16 v[24:25], v5 offset:12288
  ds_read_b64_tr_b16 v[26:27], v6 offset:12288
  ds_read_b64_tr_b16 v[28:29], v6 offset:12800
  ds_read_b64_tr_b16 v[42:43], v7 offset:12288
  ds_read_b64_tr_b16 v[44:45], v7 offset:12800
  s_waitcnt lgkmcnt(2)
  v_and_b32 v31, 0xffff0000, v24
  v_lshlrev_b32 v32, 16, v25
  v_and_b32 v33, 0xffff0000, v25
  v_lshlrev_b32 v34, 16, v26
  v_and_b32 v35, 0xffff0000, v26
  v_lshlrev_b32 v36, 16, v27
  v_and_b32 v37, 0xffff0000, v27
  v_lshlrev_b32 v38, 16, v28
  v_and_b32 v39, 0xffff0000, v28
  v_lshlrev_b32 v40, 16, v29
  v_and_b32 v41, 0xffff0000, v29
  v_mul_f32 v54, v13, v31
  v_mul_f32 v55, v13, v32
  v_mul_f32 v56, v13, v33
  v_mul_f32 v57, v13, v34
  v_mul_f32 v58, v13, v35
  v_mul_f32 v59, v13, v36
  v_mul_f32 v60, v13, v37
  v_mul_f32 v61, v13, v38
  v_fmac_f32 v54, v12, v32
  v_fmac_f32 v55, v12, v33
  v_fmac_f32 v56, v12, v34
  v_fmac_f32 v57, v12, v35
  v_fmac_f32 v58, v12, v36
  v_fmac_f32 v59, v12, v37
  v_fmac_f32 v60, v12, v38
  v_fmac_f32 v61, v12, v39
  v_fmac_f32 v54, v11, v33
  v_fmac_f32 v55, v11, v34
  v_fmac_f32 v56, v11, v35
  v_fmac_f32 v57, v11, v36
  v_fmac_f32 v58, v11, v37
  v_fmac_f32 v59, v11, v38
  v_fmac_f32 v60, v11, v39
  v_fmac_f32 v61, v11, v40
  v_fmac_f32 v54, v10, v34
  v_fmac_f32 v55, v10, v35
  v_fmac_f32 v56, v10, v36
  v_fmac_f32 v57, v10, v37
  v_fmac_f32 v58, v10, v38
  v_fmac_f32 v59, v10, v39
  v_fmac_f32 v60, v10, v40
  v_fmac_f32 v61, v10, v41
  s_waitcnt lgkmcnt(0)
  v_lshlrev_b32 v46, 16, v42
  v_and_b32 v47, 0xffff0000, v42
  v_lshlrev_b32 v48, 16, v43
  v_and_b32 v49, 0xffff0000, v43
  v_lshlrev_b32 v50, 16, v44
  v_and_b32 v51, 0xffff0000, v44
  v_lshlrev_b32 v52, 16, v45
  v_and_b32 v53, 0xffff0000, v45
  v_mul_f32 v54, v54, v46
  v_mul_f32 v55, v55, v47
  v_mul_f32 v56, v56, v48
  v_mul_f32 v57, v57, v49
  v_mul_f32 v58, v58, v50
  v_mul_f32 v59, v59, v51
  v_mul_f32 v60, v60, v52
  v_mul_f32 v61, v61, v53
  v_cvt_pk_bf16_f32 v66, v54, v55
  v_cvt_pk_bf16_f32 v67, v56, v57
  v_cvt_pk_bf16_f32 v68, v58, v59
  v_cvt_pk_bf16_f32 v69, v60, v61
  ds_write_b128 v17, v[66:69] offset:192
  v_lshrrev_b32 v18, 4, v1
  v_and_b32 v19, 15, v1
  v_mul_u32_u24 v20, 272, v18
  v_lshl_add_u32 v20, v19, 4, v20
  v_add_u32 v20, s31, v20
  s_lshl_b32 s22, s26, 6
  s_lshl_b32 s24, s34, 4
  s_add_u32 s22, s22, s24
  v_add_u32 v18, s22, v18
  v_lshlrev_b32 v18, 12, v18
  v_lshl_add_u32 v18, v19, 4, v18
  s_lshl_b32 s22, s28, 1
  s_waitcnt lgkmcnt(0)
  ds_read_b128 v[24:27], v20 offset:0
  ds_read_b128 v[28:31], v20 offset:1088
  ds_read_b128 v[32:35], v20 offset:2176
  ds_read_b128 v[36:39], v20 offset:3264
  s_waitcnt lgkmcnt(3)
  buffer_store_dwordx4 v[24:27], v18, s[8:11], s22 offen sc1
  s_add_u32 s22, s22, 16384
  s_waitcnt lgkmcnt(2)
  buffer_store_dwordx4 v[28:31], v18, s[8:11], s22 offen sc1
  s_add_u32 s22, s22, 16384
  s_waitcnt lgkmcnt(1)
  buffer_store_dwordx4 v[32:35], v18, s[8:11], s22 offen sc1
  s_add_u32 s22, s22, 16384
  s_waitcnt lgkmcnt(0)
  buffer_store_dwordx4 v[36:39], v18, s[8:11], s22 offen sc1
  s_load_dwordx4 s[44:47], s[0:1], 32
  v_lshlrev_b32 v70, 4, v1
  s_lshl_b32 s22, s30, 12
  s_waitcnt lgkmcnt(0)
  s_mov_b32 s16, s44
  s_and_b32 s17, s45, 0xffff
  s_mov_b32 s18, 2621440
  s_mov_b32 s19, 0x20000
  s_lshr_b32 s24, s30, 1
  s_lshl_b32 s24, s24, 2
  s_load_dword s37, s[46:47], s24
  s_add_u32 m0, s31, 32
  s_add_u32 s24, s22, 0
  buffer_load_dwordx4 v70, s[16:19], s24 offen nt lds
  s_add_u32 m0, s31, 1056
  s_add_u32 s24, s22, 1024
  buffer_load_dwordx4 v70, s[16:19], s24 offen nt lds
  s_add_u32 m0, s31, 2080
  s_add_u32 s24, s22, 2048
  buffer_load_dwordx4 v70, s[16:19], s24 offen nt lds
  s_add_u32 m0, s31, 3104
  s_add_u32 s24, s22, 3072
  buffer_load_dwordx4 v70, s[16:19], s24 offen nt lds
  v_mov_b32 v72, 0
  v_mov_b32 v73, 0
  v_mov_b32 v74, 0
  v_mov_b32 v75, 0
  v_add_u32 v71, s31, v70
  s_mov_b64 exec, 0x3fff
  ds_write_b128 v71, v[72:75] offset:4128
  s_mov_b64 exec, 3
  ds_write_b128 v71, v[72:75] offset:0
  s_mov_b64 exec, -1
  s_waitcnt vmcnt(8)
  v_readfirstlane_b32 s36, v77
  s_nop 0
  s_cmp_eq_u32 s36, 0
  s_cbranch_scc0 L_a_nok
  s_load_dwordx2 s[40:41], s[0:1], 80
  v_mov_b32 v78, 0
  s_waitcnt lgkmcnt(0)
an_nn38:
  global_load_dword v79, v78, s[40:41] sc1
  s_waitcnt vmcnt(0)
  v_readfirstlane_b32 s36, v79
  s_nop 0
  s_sub_u32 s99, s99, 1
  s_cbranch_scc1 L_exit
  s_cmp_eq_u32 s36, 0
  s_cbranch_scc1 an_nn38
L_a_nok:
  s_waitcnt vmcnt(4)
  s_add_u32 s22, s50, 0
  v_mov_b32 v2, s22
  v_mov_b32 v3, s36
  s_mov_b64 exec, 1
  global_store_dword v2, v3, s[38:39] sc1
  s_mov_b64 exec, -1
  s_barrier
  s_cmp_eq_u32 s33, 0
  s_cbranch_scc0 L_a_w1
  s_add_u32 s61, s63, 0
  v_min_u32 v226, 63, v1
  v_lshlrev_b32 v226, 2, v226
  v_add_u32 v226, s61, v226
pa_pl39:
  global_load_dword v227, v226, s[38:39] sc1
  s_waitcnt vmcnt(0)
  v_cmp_ne_u32 vcc, s36, v227
  s_nop 1
  s_cbranch_vccz pa_pl39d
  s_sleep 2
  s_sub_u32 s99, s99, 1
  s_cbranch_scc0 pa_pl39
  s_branch L_exit
pa_pl39d:
L_a_w1:
  s_barrier
  s_load_dwordx2 s[40:41], s[0:1], 64
  s_load_dwordx2 s[42:43], s[0:1], 0
  s_add_u32 s8, s48, 0x300000
  s_addc_u32 s9, s49, 0
  s_and_b32 s9, s9, 0xffff
  s_mov_b32 s10, 2621440
  s_mov_b32 s11, 0x20000
  s_add_u32 s12, s48, 0x600000
  s_addc_u32 s13, s49, 0
  s_and_b32 s13, s13, 0xffff
  s_mov_b32 s14, 2621440
  s_mov_b32 s15, 0x20000
  v_lshlrev_b32 v2, 4, v1
  s_lshl_b32 s22, s30, 12
  s_add_u32 m0, s31, 4352
  s_add_u32 s24, s22, 0
  buffer_load_dwordx4 v2, s[8:11], s24 offen sc1 lds
  s_add_u32 m0, s31, 5376
  s_add_u32 s24, s22, 1024
  buffer_load_dwordx4 v2, s[8:11], s24 offen sc1 lds
  s_add_u32 m0, s31, 6400
  s_add_u32 s24, s22, 2048
  buffer_load_dwordx4 v2, s[8:11], s24 offen sc1 lds
  s_add_u32 m0, s31, 7424
  s_add_u32 s24, s22, 3072
  buffer_load_dwordx4 v2, s[8:11], s24 offen sc1 lds
  v_mov_b32 v18, 0
  v_bfe_u32 v7, v1, 2, 2
  v_and_b32 v8, 3, v1
  v_lshrrev_b32 v9, 4, v1
  v_sub_u32 v3, v8, v7
  v_lshlrev_b32 v3, 3, v3
  v_lshlrev_b32 v6, 6, v9
  v_sub_u32 v3, v3, v6
  s_add_u32 s24, s31, 224
  v_add_u32 v3, s24, v3
  v_lshlrev_b32 v4, 5, v8
  v_lshl_add_u32 v4, v7, 3, v4
  v_add_u32 v4, v4, v6
  s_add_u32 s24, s31, 4128
  v_add_u32 v4, s24, v4
  v_lshlrev_b32 v7, 1, v1
  s_add_u32 s24, s31, 4352
  v_add_u32 v5, s24, v7
  v_add_u32 v6, s22, v7
  s_waitcnt vmcnt(4)
  ds_read_b64_tr_b16 v[20:21], v3 offset:32
  ds_read_b64_tr_b16 v[22:23], v3 offset:0
  ds_read_b64_tr_b16 v[24:25], v3 offset:288
  ds_read_b64_tr_b16 v[26:27], v3 offset:256
  ds_read_b64_tr_b16 v[28:29], v3 offset:544
  ds_read_b64_tr_b16 v[30:31], v3 offset:512
  ds_read_b64_tr_b16 v[32:33], v3 offset:800
  ds_read_b64_tr_b16 v[34:35], v3 offset:768
  ds_read_b64_tr_b16 v[36:37], v3 offset:1056
  ds_read_b64_tr_b16 v[38:39], v3 offset:1024
  ds_read_b64_tr_b16 v[40:41], v3 offset:1312
  ds_read_b64_tr_b16 v[42:43], v3 offset:1280
  ds_read_b64_tr_b16 v[44:45], v3 offset:1568
  ds_read_b64_tr_b16 v[46:47], v3 offset:1536
  ds_read_b64_tr_b16 v[48:49], v3 offset:1824
  ds_read_b64_tr_b16 v[50:51], v3 offset:1792
  ds_read_b64_tr_b16 v[52:53], v3 offset:2080
  ds_read_b64_tr_b16 v[54:55], v3 offset:2048
  ds_read_b64_tr_b16 v[56:57], v3 offset:2336
  ds_read_b64_tr_b16 v[58:59], v3 offset:2304
  ds_read_b64_tr_b16 v[60:61], v3 offset:2592
  ds_read_b64_tr_b16 v[62:63], v3 offset:2560
  ds_read_b64_tr_b16 v[64:65], v3 offset:2848
  ds_read_b64_tr_b16 v[66:67], v3 offset:2816
  ds_read_b64_tr_b16 v[68:69], v3 offset:3104
  ds_read_b64_tr_b16 v[70:71], v3 offset:3072
  ds_read_b64_tr_b16 v[72:73], v3 offset:3360
  ds_read_b64_tr_b16 v[74:75], v3 offset:3328
  ds_read_b64_tr_b16 v[76:77], v3 offset:3616
  ds_read_b64_tr_b16 v[78:79], v3 offset:3584
  ds_read_b64_tr_b16 v[80:81], v3 offset:3872
  ds_read_b64_tr_b16 v[82:83], v3 offset:3840
  s_and_b32 s24, s30, 1
  s_cmp_eq_u32 s24, 0
  s_cbranch_scc0 cv_dodd
  s_lshl_b32 s37, s37, 16
cv_dodd:
  s_and_b32 s37, s37, 0xffff0000
  s_waitcnt vmcnt(0)
  s_waitcnt lgkmcnt(0)
  s_mov_b32 s16, s42
  s_and_b32 s17, s43, 0xffff
  s_mov_b32 s18, 2621440
  s_mov_b32 s19, 0x20000
  v_lshrrev_b32 v232, 3, v1
  v_and_b32 v233, 7, v1
  v_xor_b32 v233, v233, v232
  s_lshl_b32 s60, s34, 4
  s_add_u32 s60, s60, s28
  v_add_u32 v232, s60, v232
  v_mul_u32_u24 v232, 1280, v232
  v_lshl_add_u32 v232, v233, 4, v232
  s_lshl_b32 s61, s26, 7
  s_add_u32 m0, s31, 0
  s_add_u32 s60, s61, 0
  buffer_load_dwordx4 v232, s[16:19], s60 offen nt lds
  s_add_u32 m0, s31, 1024
  s_add_u32 s60, s61, 10240
  buffer_load_dwordx4 v232, s[16:19], s60 offen nt lds
  s_add_u32 m0, s31, 2048
  s_add_u32 s60, s61, 81920
  buffer_load_dwordx4 v232, s[16:19], s60 offen nt lds
  s_add_u32 m0, s31, 3072
  s_add_u32 s60, s61, 92160
  buffer_load_dwordx4 v232, s[16:19], s60 offen nt lds
  v_mov_b32 v15, 0
  v_mov_b32 v16, 0
  s_cmp_eq_u32 s35, 0
  s_cbranch_scc0 cv_tm
  ds_read_b64_tr_b16 v[84:85], v4 offset:0
  ds_read_b64_tr_b16 v[86:87], v4 offset:32
  ds_read_b64_tr_b16 v[88:89], v4 offset:128
  ds_read_b64_tr_b16 v[90:91], v4 offset:160
  s_waitcnt lgkmcnt(2)
  v_mfma_f32_16x16x32_bf16 v[96:99], v[84:87], v[20:23], 0
  ds_read_b64_tr_b16 v[92:93], v4 offset:256
  ds_read_b64_tr_b16 v[94:95], v4 offset:288
  v_mfma_f32_16x16x32_bf16 v[104:107], v[84:87], v[24:27], 0
  ds_read_u16_d16_hi v15, v5 offset:0
  v_mfma_f32_16x16x32_bf16 v[112:115], v[84:87], v[28:31], 0
  v_mfma_f32_16x16x32_bf16 v[120:123], v[84:87], v[32:35], 0
  v_mfma_f32_16x16x32_bf16 v[128:131], v[84:87], v[36:39], 0
  v_mfma_f32_16x16x32_bf16 v[136:139], v[84:87], v[40:43], 0
  v_mfma_f32_16x16x32_bf16 v[144:147], v[84:87], v[44:47], 0
  v_mfma_f32_16x16x32_bf16 v[152:155], v[84:87], v[48:51], 0
  v_mfma_f32_16x16x32_bf16 v[160:163], v[84:87], v[52:55], 0
  v_mfma_f32_16x16x32_bf16 v[168:171], v[84:87], v[56:59], 0
  v_mfma_f32_16x16x32_bf16 v[176:179], v[84:87], v[60:63], 0
  v_mfma_f32_16x16x32_bf16 v[184:187], v[84:87], v[64:67], 0
  v_mfma_f32_16x16x32_bf16 v[192:195], v[84:87], v[68:71], 0
  v_mfma_f32_16x16x32_bf16 v[200:203], v[84:87], v[72:75], 0
  v_mfma_f32_16x16x32_bf16 v[208:211], v[84:87], v[76:79], 0
  v_mfma_f32_16x16x32_bf16 v[216:219], v[84:87], v[80:83], 0
  s_waitcnt lgkmcnt(3)
  v_mfma_f32_16x16x32_bf16 v[100:103], v[88:91], v[20:23], 0
  ds_read_b64_tr_b16 v[84:85], v4 offset:384
  ds_read_b64_tr_b16 v[86:87], v4 offset:416
  v_mfma_f32_16x16x32_bf16 v[108:111], v[88:91], v[24:27], 0
  ds_read_u16_d16_hi v16, v5 offset:128
  v_add_f32_dpp v10, v18, v98 wave_ror:1 row_mask:0xf bank_mask:0xf
  v_mfma_f32_16x16x32_bf16 v[116:119], v[88:91], v[28:31], 0
  v_add_f32_dpp v10, v99, v98 wave_shr:1 row_mask:0xf bank_mask:0xf
  v_add_f32_dpp v12, v18, v97 wave_ror:1 row_mask:0xf bank_mask:0xf
  v_mfma_f32_16x16x32_bf16 v[124:127], v[88:91], v[32:35], 0
  v_add_f32_dpp v12, v10, v97 wave_shr:1 row_mask:0xf bank_mask:0xf
  v_add_f32_dpp v14, v18, v96 wave_ror:1 row_mask:0xf bank_mask:0xf
  v_mfma_f32_16x16x32_bf16 v[132:135], v[88:91], v[36:39], 0
  v_add_f32_dpp v14, v12, v96 wave_shr:1 row_mask:0xf bank_mask:0xf
  s_waitcnt lgkmcnt(3)
  v_mfma_f32_16x16x32_bf16 v[140:143], v[88:91], v[40:43], 0
  v_fma_f32 v14, v15, s37, v14
  v_cvt_pk_bf16_f32 v96, v14, v14
  v_mfma_f32_16x16x32_bf16 v[148:151], v[88:91], v[44:47], 0
  buffer_store_short v96, v6, s[12:15], 0 offen offset:0 sc1
  v_mfma_f32_16x16x32_bf16 v[156:159], v[88:91], v[48:51], 0
  v_mfma_f32_16x16x32_bf16 v[164:167], v[88:91], v[52:55], 0
  v_mfma_f32_16x16x32_bf16 v[172:175], v[88:91], v[56:59], 0
  v_mfma_f32_16x16x32_bf16 v[180:183], v[88:91], v[60:63], 0
  v_mfma_f32_16x16x32_bf16 v[188:191], v[88:91], v[64:67], 0
  v_mfma_f32_16x16x32_bf16 v[196:199], v[88:91], v[68:71], 0
  v_mfma_f32_16x16x32_bf16 v[204:207], v[88:91], v[72:75], 0
  v_mfma_f32_16x16x32_bf16 v[212:215], v[88:91], v[76:79], 0
  v_mfma_f32_16x16x32_bf16 v[220:223], v[88:91], v[80:83], 0
  s_waitcnt lgkmcnt(4)
  v_mfma_f32_16x16x32_bf16 v[104:107], v[92:95], v[20:23], v[104:107]
  ds_read_b64_tr_b16 v[88:89], v4 offset:512
  ds_read_b64_tr_b16 v[90:91], v4 offset:544
  v_mfma_f32_16x16x32_bf16 v[112:115], v[92:95], v[24:27], v[112:115]
  ds_read_u16_d16_hi v15, v5 offset:256
  v_add_f32_dpp v11, v99, v102 wave_ror:1 row_mask:0xf bank_mask:0xf
  v_mfma_f32_16x16x32_bf16 v[120:123], v[92:95], v[28:31], v[120:123]
  v_add_f32_dpp v11, v103, v102 wave_shr:1 row_mask:0xf bank_mask:0xf
  v_add_f32_dpp v13, v10, v101 wave_ror:1 row_mask:0xf bank_mask:0xf
  v_mfma_f32_16x16x32_bf16 v[128:131], v[92:95], v[32:35], v[128:131]
  v_add_f32_dpp v13, v11, v101 wave_shr:1 row_mask:0xf bank_mask:0xf
  v_add_f32_dpp v14, v12, v100 wave_ror:1 row_mask:0xf bank_mask:0xf
  v_mfma_f32_16x16x32_bf16 v[136:139], v[92:95], v[36:39], v[136:139]
  v_add_f32_dpp v14, v13, v100 wave_shr:1 row_mask:0xf bank_mask:0xf
  s_waitcnt lgkmcnt(3)
  v_mfma_f32_16x16x32_bf16 v[144:147], v[92:95], v[40:43], v[144:147]
  v_fma_f32 v14, v16, s37, v14
  v_cvt_pk_bf16_f32 v100, v14, v14
  v_mfma_f32_16x16x32_bf16 v[152:155], v[92:95], v[44:47], v[152:155]
  buffer_store_short v100, v6, s[12:15], 0 offen offset:128 sc1
  v_mfma_f32_16x16x32_bf16 v[160:163], v[92:95], v[48:51], v[160:163]
  v_mfma_f32_16x16x32_bf16 v[168:171], v[92:95], v[52:55], v[168:171]
  v_mfma_f32_16x16x32_bf16 v[176:179], v[92:95], v[56:59], v[176:179]
  v_mfma_f32_16x16x32_bf16 v[184:187], v[92:95], v[60:63], v[184:187]
  v_mfma_f32_16x16x32_bf16 v[192:195], v[92:95], v[64:67], v[192:195]
  v_mfma_f32_16x16x32_bf16 v[200:203], v[92:95], v[68:71], v[200:203]
  v_mfma_f32_16x16x32_bf16 v[208:211], v[92:95], v[72:75], v[208:211]
  v_mfma_f32_16x16x32_bf16 v[216:219], v[92:95], v[76:79], v[216:219]
  s_waitcnt lgkmcnt(4)
  v_mfma_f32_16x16x32_bf16 v[108:111], v[84:87], v[20:23], v[108:111]
  ds_read_b64_tr_b16 v[92:93], v4 offset:640
  ds_read_b64_tr_b16 v[94:95], v4 offset:672
  v_mfma_f32_16x16x32_bf16 v[116:119], v[84:87], v[24:27], v[116:119]
  ds_read_u16_d16_hi v16, v5 offset:384
  v_add_f32_dpp v10, v103, v106 wave_ror:1 row_mask:0xf bank_mask:0xf
  v_mfma_f32_16x16x32_bf16 v[124:127], v[84:87], v[28:31], v[124:127]
  v_add_f32_dpp v10, v107, v106 wave_shr:1 row_mask:0xf bank_mask:0xf
  v_add_f32_dpp v12, v11, v105 wave_ror:1 row_mask:0xf bank_mask:0xf
  v_mfma_f32_16x16x32_bf16 v[132:135], v[84:87], v[32:35], v[132:135]
  v_add_f32_dpp v12, v10, v105 wave_shr:1 row_mask:0xf bank_mask:0xf
  v_add_f32_dpp v14, v13, v104 wave_ror:1 row_mask:0xf bank_mask:0xf
  v_mfma_f32_16x16x32_bf16 v[140:143], v[84:87], v[36:39], v[140:143]
  v_add_f32_dpp v14, v12, v104 wave_shr:1 row_mask:0xf bank_mask:0xf
  s_waitcnt lgkmcnt(3)
  v_mfma_f32_16x16x32_bf16 v[148:151], v[84:87], v[40:43], v[148:151]
  v_fma_f32 v14, v15, s37, v14
  v_cvt_pk_bf16_f32 v104, v14, v14
  v_mfma_f32_16x16x32_bf16 v[156:159], v[84:87], v[44:47], v[156:159]
  buffer_store_short v104, v6, s[12:15], 0 offen offset:256 sc1
  v_mfma_f32_16x16x32_bf16 v[164:167], v[84:87], v[48:51], v[164:167]
  v_mfma_f32_16x16x32_bf16 v[172:175], v[84:87], v[52:55], v[172:175]
  v_mfma_f32_16x16x32_bf16 v[180:183], v[84:87], v[56:59], v[180:183]
  v_mfma_f32_16x16x32_bf16 v[188:191], v[84:87], v[60:63], v[188:191]
  v_mfma_f32_16x16x32_bf16 v[196:199], v[84:87], v[64:67], v[196:199]
  v_mfma_f32_16x16x32_bf16 v[204:207], v[84:87], v[68:71], v[204:207]
  v_mfma_f32_16x16x32_bf16 v[212:215], v[84:87], v[72:75], v[212:215]
  v_mfma_f32_16x16x32_bf16 v[220:223], v[84:87], v[76:79], v[220:223]
  s_waitcnt lgkmcnt(4)
  v_mfma_f32_16x16x32_bf16 v[112:115], v[88:91], v[20:23], v[112:115]
  ds_read_b64_tr_b16 v[84:85], v4 offset:768
  ds_read_b64_tr_b16 v[86:87], v4 offset:800
  v_mfma_f32_16x16x32_bf16 v[120:123], v[88:91], v[24:27], v[120:123]
  ds_read_u16_d16_hi v15, v5 offset:512
  v_add_f32_dpp v11, v107, v110 wave_ror:1 row_mask:0xf bank_mask:0xf
  v_mfma_f32_16x16x32_bf16 v[128:131], v[88:91], v[28:31], v[128:131]
  v_add_f32_dpp v11, v111, v110 wave_shr:1 row_mask:0xf bank_mask:0xf
  v_add_f32_dpp v13, v10, v109 wave_ror:1 row_mask:0xf bank_mask:0xf
  v_mfma_f32_16x16x32_bf16 v[136:139], v[88:91], v[32:35], v[136:139]
  v_add_f32_dpp v13, v11, v109 wave_shr:1 row_mask:0xf bank_mask:0xf
  v_add_f32_dpp v14, v12, v108 wave_ror:1 row_mask:0xf bank_mask:0xf
  v_mfma_f32_16x16x32_bf16 v[144:147], v[88:91], v[36:39], v[144:147]
  v_add_f32_dpp v14, v13, v108 wave_shr:1 row_mask:0xf bank_mask:0xf
  s_waitcnt lgkmcnt(3)
  v_mfma_f32_16x16x32_bf16 v[152:155], v[88:91], v[40:43], v[152:155]
  v_fma_f32 v14, v16, s37, v14
  v_cvt_pk_bf16_f32 v108, v14, v14
  v_mfma_f32_16x16x32_bf16 v[160:163], v[88:91], v[44:47], v[160:163]
  buffer_store_short v108, v6, s[12:15], 0 offen offset:384 sc1
  v_mfma_f32_16x16x32_bf16 v[168:171], v[88:91], v[48:51], v[168:171]
  v_mfma_f32_16x16x32_bf16 v[176:179], v[88:91], v[52:55], v[176:179]
  v_mfma_f32_16x16x32_bf16 v[184:187], v[88:91], v[56:59], v[184:187]
  v_mfma_f32_16x16x32_bf16 v[192:195], v[88:91], v[60:63], v[192:195]
  v_mfma_f32_16x16x32_bf16 v[200:203], v[88:91], v[64:67], v[200:203]
  v_mfma_f32_16x16x32_bf16 v[208:211], v[88:91], v[68:71], v[208:211]
  v_mfma_f32_16x16x32_bf16 v[216:219], v[88:91], v[72:75], v[216:219]
  s_waitcnt lgkmcnt(4)
  v_mfma_f32_16x16x32_bf16 v[116:119], v[92:95], v[20:23], v[116:119]
  ds_read_b64_tr_b16 v[88:89], v4 offset:896
  ds_read_b64_tr_b16 v[90:91], v4 offset:928
  v_mfma_f32_16x16x32_bf16 v[124:127], v[92:95], v[24:27], v[124:127]
  ds_read_u16_d16_hi v16, v5 offset:640
  v_add_f32_dpp v10, v111, v114 wave_ror:1 row_mask:0xf bank_mask:0xf
  v_mfma_f32_16x16x32_bf16 v[132:135], v[92:95], v[28:31], v[132:135]
  v_add_f32_dpp v10, v115, v114 wave_shr:1 row_mask:0xf bank_mask:0xf
  v_add_f32_dpp v12, v11, v113 wave_ror:1 row_mask:0xf bank_mask:0xf
  v_mfma_f32_16x16x32_bf16 v[140:143], v[92:95], v[32:35], v[140:143]
  v_add_f32_dpp v12, v10, v113 wave_shr:1 row_mask:0xf bank_mask:0xf
  v_add_f32_dpp v14, v13, v112 wave_ror:1 row_mask:0xf bank_mask:0xf
  v_mfma_f32_16x16x32_bf16 v[148:151], v[92:95], v[36:39], v[148:151]
  v_add_f32_dpp v14, v12, v112 wave_shr:1 row_mask:0xf bank_mask:0xf
  s_waitcnt lgkmcnt(3)
  v_mfma_f32_16x16x32_bf16 v[156:159], v[92:95], v[40:43], v[156:159]
  v_fma_f32 v14, v15, s37, v14
  v_cvt_pk_bf16_f32 v112, v14, v14
  v_mfma_f32_16x16x32_bf16 v[164:167], v[92:95], v[44:47], v[164:167]
  buffer_store_short v112, v6, s[12:15], 0 offen offset:512 sc1
  v_mfma_f32_16x16x32_bf16 v[172:175], v[92:95], v[48:51], v[172:175]
  v_mfma_f32_16x16x32_bf16 v[180:183], v[92:95], v[52:55], v[180:183]
  v_mfma_f32_16x16x32_bf16 v[188:191], v[92:95], v[56:59], v[188:191]
  v_mfma_f32_16x16x32_bf16 v[196:199], v[92:95], v[60:63], v[196:199]
  v_mfma_f32_16x16x32_bf16 v[204:207], v[92:95], v[64:67], v[204:207]
  v_mfma_f32_16x16x32_bf16 v[212:215], v[92:95], v[68:71], v[212:215]
  v_mfma_f32_16x16x32_bf16 v[220:223], v[92:95], v[72:75], v[220:223]
  s_waitcnt lgkmcnt(4)
  v_mfma_f32_16x16x32_bf16 v[120:123], v[84:87], v[20:23], v[120:123]
  ds_read_b64_tr_b16 v[92:93], v4 offset:1024
  ds_read_b64_tr_b16 v[94:95], v4 offset:1056
  v_mfma_f32_16x16x32_bf16 v[128:131], v[84:87], v[24:27], v[128:131]
  ds_read_u16_d16_hi v15, v5 offset:768
  v_add_f32_dpp v11, v115, v118 wave_ror:1 row_mask:0xf bank_mask:0xf
  v_mfma_f32_16x16x32_bf16 v[136:139], v[84:87], v[28:31], v[136:139]
  v_add_f32_dpp v11, v119, v118 wave_shr:1 row_mask:0xf bank_mask:0xf
  v_add_f32_dpp v13, v10, v117 wave_ror:1 row_mask:0xf bank_mask:0xf
  v_mfma_f32_16x16x32_bf16 v[144:147], v[84:87], v[32:35], v[144:147]
  v_add_f32_dpp v13, v11, v117 wave_shr:1 row_mask:0xf bank_mask:0xf
  v_add_f32_dpp v14, v12, v116 wave_ror:1 row_mask:0xf bank_mask:0xf
  v_mfma_f32_16x16x32_bf16 v[152:155], v[84:87], v[36:39], v[152:155]
  v_add_f32_dpp v14, v13, v116 wave_shr:1 row_mask:0xf bank_mask:0xf
  s_waitcnt lgkmcnt(3)
  v_mfma_f32_16x16x32_bf16 v[160:163], v[84:87], v[40:43], v[160:163]
  v_fma_f32 v14, v16, s37, v14
  v_cvt_pk_bf16_f32 v116, v14, v14
  v_mfma_f32_16x16x32_bf16 v[168:171], v[84:87], v[44:47], v[168:171]
  buffer_store_short v116, v6, s[12:15], 0 offen offset:640 sc1
  v_mfma_f32_16x16x32_bf16 v[176:179], v[84:87], v[48:51], v[176:179]
  v_mfma_f32_16x16x32_bf16 v[184:187], v[84:87], v[52:55], v[184:187]
  v_mfma_f32_16x16x32_bf16 v[192:195], v[84:87], v[56:59], v[192:195]
  v_mfma_f32_16x16x32_bf16 v[200:203], v[84:87], v[60:63], v[200:203]
  v_mfma_f32_16x16x32_bf16 v[208:211], v[84:87], v[64:67], v[208:211]
  v_mfma_f32_16x16x32_bf16 v[216:219], v[84:87], v[68:71], v[216:219]
  s_waitcnt lgkmcnt(4)
  v_mfma_f32_16x16x32_bf16 v[124:127], v[88:91], v[20:23], v[124:127]
  ds_read_b64_tr_b16 v[84:85], v4 offset:1152
  ds_read_b64_tr_b16 v[86:87], v4 offset:1184
  v_mfma_f32_16x16x32_bf16 v[132:135], v[88:91], v[24:27], v[132:135]
  ds_read_u16_d16_hi v16, v5 offset:896
  v_add_f32_dpp v10, v119, v122 wave_ror:1 row_mask:0xf bank_mask:0xf
  v_mfma_f32_16x16x32_bf16 v[140:143], v[88:91], v[28:31], v[140:143]
  v_add_f32_dpp v10, v123, v122 wave_shr:1 row_mask:0xf bank_mask:0xf
  v_add_f32_dpp v12, v11, v121 wave_ror:1 row_mask:0xf bank_mask:0xf
  v_mfma_f32_16x16x32_bf16 v[148:151], v[88:91], v[32:35], v[148:151]
  v_add_f32_dpp v12, v10, v121 wave_shr:1 row_mask:0xf bank_mask:0xf
  v_add_f32_dpp v14, v13, v120 wave_ror:1 row_mask:0xf bank_mask:0xf
  v_mfma_f32_16x16x32_bf16 v[156:159], v[88:91], v[36:39], v[156:159]
  v_add_f32_dpp v14, v12, v120 wave_shr:1 row_mask:0xf bank_mask:0xf
  s_waitcnt lgkmcnt(3)
  v_mfma_f32_16x16x32_bf16 v[164:167], v[88:91], v[40:43], v[164:167]
  v_fma_f32 v14, v15, s37, v14
  v_cvt_pk_bf16_f32 v120, v14, v14
  v_mfma_f32_16x16x32_bf16 v[172:175], v[88:91], v[44:47], v[172:175]
  buffer_store_short v120, v6, s[12:15], 0 offen offset:768 sc1
  v_mfma_f32_16x16x32_bf16 v[180:183], v[88:91], v[48:51], v[180:183]
  v_mfma_f32_16x16x32_bf16 v[188:191], v[88:91], v[52:55], v[188:191]
  v_mfma_f32_16x16x32_bf16 v[196:199], v[88:91], v[56:59], v[196:199]
  v_mfma_f32_16x16x32_bf16 v[204:207], v[88:91], v[60:63], v[204:207]
  v_mfma_f32_16x16x32_bf16 v[212:215], v[88:91], v[64:67], v[212:215]
  v_mfma_f32_16x16x32_bf16 v[220:223], v[88:91], v[68:71], v[220:223]
  s_waitcnt lgkmcnt(4)
  v_mfma_f32_16x16x32_bf16 v[128:131], v[92:95], v[20:23], v[128:131]
  ds_read_b64_tr_b16 v[88:89], v4 offset:1280
  ds_read_b64_tr_b16 v[90:91], v4 offset:1312
  v_mfma_f32_16x16x32_bf16 v[136:139], v[92:95], v[24:27], v[136:139]
  ds_read_u16_d16_hi v15, v5 offset:1024
  v_add_f32_dpp v11, v123, v126 wave_ror:1 row_mask:0xf bank_mask:0xf
  v_mfma_f32_16x16x32_bf16 v[144:147], v[92:95], v[28:31], v[144:147]
  v_add_f32_dpp v11, v127, v126 wave_shr:1 row_mask:0xf bank_mask:0xf
  v_add_f32_dpp v13, v10, v125 wave_ror:1 row_mask:0xf bank_mask:0xf
  v_mfma_f32_16x16x32_bf16 v[152:155], v[92:95], v[32:35], v[152:155]
  v_add_f32_dpp v13, v11, v125 wave_shr:1 row_mask:0xf bank_mask:0xf
  v_add_f32_dpp v14, v12, v124 wave_ror:1 row_mask:0xf bank_mask:0xf
  v_mfma_f32_16x16x32_bf16 v[160:163], v[92:95], v[36:39], v[160:163]
  v_add_f32_dpp v14, v13, v124 wave_shr:1 row_mask:0xf bank_mask:0xf
  s_waitcnt lgkmcnt(3)
  v_mfma_f32_16x16x32_bf16 v[168:171], v[92:95], v[40:43], v[168:171]
  v_fma_f32 v14, v16, s37, v14
  v_cvt_pk_bf16_f32 v124, v14, v14
  v_mfma_f32_16x16x32_bf16 v[176:179], v[92:95], v[44:47], v[176:179]
  buffer_store_short v124, v6, s[12:15], 0 offen offset:896 sc1
  v_mfma_f32_16x16x32_bf16 v[184:187], v[92:95], v[48:51], v[184:187]
  v_mfma_f32_16x16x32_bf16 v[192:195], v[92:95], v[52:55], v[192:195]
  v_mfma_f32_16x16x32_bf16 v[200:203], v[92:95], v[56:59], v[200:203]
  v_mfma_f32_16x16x32_bf16 v[208:211], v[92:95], v[60:63], v[208:211]
  v_mfma_f32_16x16x32_bf16 v[216:219], v[92:95], v[64:67], v[216:219]
  s_waitcnt lgkmcnt(4)
  v_mfma_f32_16x16x32_bf16 v[132:135], v[84:87], v[20:23], v[132:135]
  ds_read_b64_tr_b16 v[92:93], v4 offset:1408
  ds_read_b64_tr_b16 v[94:95], v4 offset:1440
  v_mfma_f32_16x16x32_bf16 v[140:143], v[84:87], v[24:27], v[140:143]
  ds_read_u16_d16_hi v16, v5 offset:1152
  v_add_f32_dpp v10, v127, v130 wave_ror:1 row_mask:0xf bank_mask:0xf
  v_mfma_f32_16x16x32_bf16 v[148:151], v[84:87], v[28:31], v[148:151]
  v_add_f32_dpp v10, v131, v130 wave_shr:1 row_mask:0xf bank_mask:0xf
  v_add_f32_dpp v12, v11, v129 wave_ror:1 row_mask:0xf bank_mask:0xf
  v_mfma_f32_16x16x32_bf16 v[156:159], v[84:87], v[32:35], v[156:159]
  v_add_f32_dpp v12, v10, v129 wave_shr:1 row_mask:0xf bank_mask:0xf
  v_add_f32_dpp v14, v13, v128 wave_ror:1 row_mask:0xf bank_mask:0xf
  v_mfma_f32_16x16x32_bf16 v[164:167], v[84:87], v[36:39], v[164:167]
  v_add_f32_dpp v14, v12, v128 wave_shr:1 row_mask:0xf bank_mask:0xf
  s_waitcnt lgkmcnt(3)
  v_mfma_f32_16x16x32_bf16 v[172:175], v[84:87], v[40:43], v[172:175]
  v_fma_f32 v14, v15, s37, v14
  v_cvt_pk_bf16_f32 v128, v14, v14
  v_mfma_f32_16x16x32_bf16 v[180:183], v[84:87], v[44:47], v[180:183]
  buffer_store_short v128, v6, s[12:15], 0 offen offset:1024 sc1
  v_mfma_f32_16x16x32_bf16 v[188:191], v[84:87], v[48:51], v[188:191]
  v_mfma_f32_16x16x32_bf16 v[196:199], v[84:87], v[52:55], v[196:199]
  v_mfma_f32_16x16x32_bf16 v[204:207], v[84:87], v[56:59], v[204:207]
  v_mfma_f32_16x16x32_bf16 v[212:215], v[84:87], v[60:63], v[212:215]
  v_mfma_f32_16x16x32_bf16 v[220:223], v[84:87], v[64:67], v[220:223]
  s_waitcnt lgkmcnt(4)
  v_mfma_f32_16x16x32_bf16 v[136:139], v[88:91], v[20:23], v[136:139]
  ds_read_b64_tr_b16 v[84:85], v4 offset:1536
  ds_read_b64_tr_b16 v[86:87], v4 offset:1568
  v_mfma_f32_16x16x32_bf16 v[144:147], v[88:91], v[24:27], v[144:147]
  ds_read_u16_d16_hi v15, v5 offset:1280
  v_add_f32_dpp v11, v131, v134 wave_ror:1 row_mask:0xf bank_mask:0xf
  v_mfma_f32_16x16x32_bf16 v[152:155], v[88:91], v[28:31], v[152:155]
  v_add_f32_dpp v11, v135, v134 wave_shr:1 row_mask:0xf bank_mask:0xf
  v_add_f32_dpp v13, v10, v133 wave_ror:1 row_mask:0xf bank_mask:0xf
  v_mfma_f32_16x16x32_bf16 v[160:163], v[88:91], v[32:35], v[160:163]
  v_add_f32_dpp v13, v11, v133 wave_shr:1 row_mask:0xf bank_mask:0xf
  v_add_f32_dpp v14, v12, v132 wave_ror:1 row_mask:0xf bank_mask:0xf
  v_mfma_f32_16x16x32_bf16 v[168:171], v[88:91], v[36:39], v[168:171]
  v_add_f32_dpp v14, v13, v132 wave_shr:1 row_mask:0xf bank_mask:0xf
  s_waitcnt lgkmcnt(3)
  v_mfma_f32_16x16x32_bf16 v[176:179], v[88:91], v[40:43], v[176:179]
  v_fma_f32 v14, v16, s37, v14
  v_cvt_pk_bf16_f32 v132, v14, v14
  v_mfma_f32_16x16x32_bf16 v[184:187], v[88:91], v[44:47], v[184:187]
  buffer_store_short v132, v6, s[12:15], 0 offen offset:1152 sc1
  v_mfma_f32_16x16x32_bf16 v[192:195], v[88:91], v[48:51], v[192:195]
  v_mfma_f32_16x16x32_bf16 v[200:203], v[88:91], v[52:55], v[200:203]
  v_mfma_f32_16x16x32_bf16 v[208:211], v[88:91], v[56:59], v[208:211]
  v_mfma_f32_16x16x32_bf16 v[216:219], v[88:91], v[60:63], v[216:219]
  s_waitcnt lgkmcnt(4)
  v_mfma_f32_16x16x32_bf16 v[140:143], v[92:95], v[20:23], v[140:143]
  ds_read_b64_tr_b16 v[88:89], v4 offset:1664
  ds_read_b64_tr_b16 v[90:91], v4 offset:1696
  v_mfma_f32_16x16x32_bf16 v[148:151], v[92:95], v[24:27], v[148:151]
  ds_read_u16_d16_hi v16, v5 offset:1408
  v_add_f32_dpp v10, v135, v138 wave_ror:1 row_mask:0xf bank_mask:0xf
  v_mfma_f32_16x16x32_bf16 v[156:159], v[92:95], v[28:31], v[156:159]
  v_add_f32_dpp v10, v139, v138 wave_shr:1 row_mask:0xf bank_mask:0xf
  v_add_f32_dpp v12, v11, v137 wave_ror:1 row_mask:0xf bank_mask:0xf
  v_mfma_f32_16x16x32_bf16 v[164:167], v[92:95], v[32:35], v[164:167]
  v_add_f32_dpp v12, v10, v137 wave_shr:1 row_mask:0xf bank_mask:0xf
  v_add_f32_dpp v14, v13, v136 wave_ror:1 row_mask:0xf bank_mask:0xf
  v_mfma_f32_16x16x32_bf16 v[172:175], v[92:95], v[36:39], v[172:175]
  v_add_f32_dpp v14, v12, v136 wave_shr:1 row_mask:0xf bank_mask:0xf
  s_waitcnt lgkmcnt(3)
  v_mfma_f32_16x16x32_bf16 v[180:183], v[92:95], v[40:43], v[180:183]
  v_fma_f32 v14, v15, s37, v14
  v_cvt_pk_bf16_f32 v136, v14, v14
  v_mfma_f32_16x16x32_bf16 v[188:191], v[92:95], v[44:47], v[188:191]
  buffer_store_short v136, v6, s[12:15], 0 offen offset:1280 sc1
  v_mfma_f32_16x16x32_bf16 v[196:199], v[92:95], v[48:51], v[196:199]
  v_mfma_f32_16x16x32_bf16 v[204:207], v[92:95], v[52:55], v[204:207]
  v_mfma_f32_16x16x32_bf16 v[212:215], v[92:95], v[56:59], v[212:215]
  v_mfma_f32_16x16x32_bf16 v[220:223], v[92:95], v[60:63], v[220:223]
  s_waitcnt lgkmcnt(4)
  v_mfma_f32_16x16x32_bf16 v[144:147], v[84:87], v[20:23], v[144:147]
  ds_read_b64_tr_b16 v[92:93], v4 offset:1792
  ds_read_b64_tr_b16 v[94:95], v4 offset:1824
  v_mfma_f32_16x16x32_bf16 v[152:155], v[84:87], v[24:27], v[152:155]
  ds_read_u16_d16_hi v15, v5 offset:1536
  v_add_f32_dpp v11, v139, v142 wave_ror:1 row_mask:0xf bank_mask:0xf
  v_mfma_f32_16x16x32_bf16 v[160:163], v[84:87], v[28:31], v[160:163]
  v_add_f32_dpp v11, v143, v142 wave_shr:1 row_mask:0xf bank_mask:0xf
  v_add_f32_dpp v13, v10, v141 wave_ror:1 row_mask:0xf bank_mask:0xf
  v_mfma_f32_16x16x32_bf16 v[168:171], v[84:87], v[32:35], v[168:171]
  v_add_f32_dpp v13, v11, v141 wave_shr:1 row_mask:0xf bank_mask:0xf
  v_add_f32_dpp v14, v12, v140 wave_ror:1 row_mask:0xf bank_mask:0xf
  v_mfma_f32_16x16x32_bf16 v[176:179], v[84:87], v[36:39], v[176:179]
  v_add_f32_dpp v14, v13, v140 wave_shr:1 row_mask:0xf bank_mask:0xf
  s_waitcnt lgkmcnt(3)
  v_mfma_f32_16x16x32_bf16 v[184:187], v[84:87], v[40:43], v[184:187]
  v_fma_f32 v14, v16, s37, v14
  v_cvt_pk_bf16_f32 v140, v14, v14
  v_mfma_f32_16x16x32_bf16 v[192:195], v[84:87], v[44:47], v[192:195]
  buffer_store_short v140, v6, s[12:15], 0 offen offset:1408 sc1
  v_mfma_f32_16x16x32_bf16 v[200:203], v[84:87], v[48:51], v[200:203]
  v_mfma_f32_16x16x32_bf16 v[208:211], v[84:87], v[52:55], v[208:211]
  v_mfma_f32_16x16x32_bf16 v[216:219], v[84:87], v[56:59], v[216:219]
  s_waitcnt lgkmcnt(4)
  v_mfma_f32_16x16x32_bf16 v[148:151], v[88:91], v[20:23], v[148:151]
  ds_read_b64_tr_b16 v[84:85], v4 offset:1920
  ds_read_b64_tr_b16 v[86:87], v4 offset:1952
  v_mfma_f32_16x16x32_bf16 v[156:159], v[88:91], v[24:27], v[156:159]
  ds_read_u16_d16_hi v16, v5 offset:1664
  v_add_f32_dpp v10, v143, v146 wave_ror:1 row_mask:0xf bank_mask:0xf
  v_mfma_f32_16x16x32_bf16 v[164:167], v[88:91], v[28:31], v[164:167]
  v_add_f32_dpp v10, v147, v146 wave_shr:1 row_mask:0xf bank_mask:0xf
  v_add_f32_dpp v12, v11, v145 wave_ror:1 row_mask:0xf bank_mask:0xf
  v_mfma_f32_16x16x32_bf16 v[172:175], v[88:91], v[32:35], v[172:175]
  v_add_f32_dpp v12, v10, v145 wave_shr:1 row_mask:0xf bank_mask:0xf
  v_add_f32_dpp v14, v13, v144 wave_ror:1 row_mask:0xf bank_mask:0xf
  v_mfma_f32_16x16x32_bf16 v[180:183], v[88:91], v[36:39], v[180:183]
  v_add_f32_dpp v14, v12, v144 wave_shr:1 row_mask:0xf bank_mask:0xf
  s_waitcnt lgkmcnt(3)
  v_mfma_f32_16x16x32_bf16 v[188:191], v[88:91], v[40:43], v[188:191]
  v_fma_f32 v14, v15, s37, v14
  v_cvt_pk_bf16_f32 v144, v14, v14
  v_mfma_f32_16x16x32_bf16 v[196:199], v[88:91], v[44:47], v[196:199]
  buffer_store_short v144, v6, s[12:15], 0 offen offset:1536 sc1
  v_mfma_f32_16x16x32_bf16 v[204:207], v[88:91], v[48:51], v[204:207]
  v_mfma_f32_16x16x32_bf16 v[212:215], v[88:91], v[52:55], v[212:215]
  v_mfma_f32_16x16x32_bf16 v[220:223], v[88:91], v[56:59], v[220:223]
  s_waitcnt lgkmcnt(4)
  v_mfma_f32_16x16x32_bf16 v[152:155], v[92:95], v[20:23], v[152:155]
  ds_read_b64_tr_b16 v[88:89], v4 offset:2048
  ds_read_b64_tr_b16 v[90:91], v4 offset:2080
  v_mfma_f32_16x16x32_bf16 v[160:163], v[92:95], v[24:27], v[160:163]
  ds_read_u16_d16_hi v15, v5 offset:1792
  v_add_f32_dpp v11, v147, v150 wave_ror:1 row_mask:0xf bank_mask:0xf
  v_mfma_f32_16x16x32_bf16 v[168:171], v[92:95], v[28:31], v[168:171]
  v_add_f32_dpp v11, v151, v150 wave_shr:1 row_mask:0xf bank_mask:0xf
  v_add_f32_dpp v13, v10, v149 wave_ror:1 row_mask:0xf bank_mask:0xf
  v_mfma_f32_16x16x32_bf16 v[176:179], v[92:95], v[32:35], v[176:179]
  v_add_f32_dpp v13, v11, v149 wave_shr:1 row_mask:0xf bank_mask:0xf
  v_add_f32_dpp v14, v12, v148 wave_ror:1 row_mask:0xf bank_mask:0xf
  v_mfma_f32_16x16x32_bf16 v[184:187], v[92:95], v[36:39], v[184:187]
  v_add_f32_dpp v14, v13, v148 wave_shr:1 row_mask:0xf bank_mask:0xf
  s_waitcnt lgkmcnt(3)
  v_mfma_f32_16x16x32_bf16 v[192:195], v[92:95], v[40:43], v[192:195]
  v_fma_f32 v14, v16, s37, v14
  v_cvt_pk_bf16_f32 v148, v14, v14
  v_mfma_f32_16x16x32_bf16 v[200:203], v[92:95], v[44:47], v[200:203]
  buffer_store_short v148, v6, s[12:15], 0 offen offset:1664 sc1
  v_mfma_f32_16x16x32_bf16 v[208:211], v[92:95], v[48:51], v[208:211]
  v_mfma_f32_16x16x32_bf16 v[216:219], v[92:95], v[52:55], v[216:219]
  s_waitcnt lgkmcnt(4)
  v_mfma_f32_16x16x32_bf16 v[156:159], v[84:87], v[20:23], v[156:159]
  ds_read_b64_tr_b16 v[92:93], v4 offset:2176
  ds_read_b64_tr_b16 v[94:95], v4 offset:2208
  v_mfma_f32_16x16x32_bf16 v[164:167], v[84:87], v[24:27], v[164:167]
  ds_read_u16_d16_hi v16, v5 offset:1920
  v_add_f32_dpp v10, v151, v154 wave_ror:1 row_mask:0xf bank_mask:0xf
  v_mfma_f32_16x16x32_bf16 v[172:175], v[84:87], v[28:31], v[172:175]
  v_add_f32_dpp v10, v155, v154 wave_shr:1 row_mask:0xf bank_mask:0xf
  v_add_f32_dpp v12, v11, v153 wave_ror:1 row_mask:0xf bank_mask:0xf
  v_mfma_f32_16x16x32_bf16 v[180:183], v[84:87], v[32:35], v[180:183]
  v_add_f32_dpp v12, v10, v153 wave_shr:1 row_mask:0xf bank_mask:0xf
  v_add_f32_dpp v14, v13, v152 wave_ror:1 row_mask:0xf bank_mask:0xf
  v_mfma_f32_16x16x32_bf16 v[188:191], v[84:87], v[36:39], v[188:191]
  v_add_f32_dpp v14, v12, v152 wave_shr:1 row_mask:0xf bank_mask:0xf
  s_waitcnt lgkmcnt(3)
  v_mfma_f32_16x16x32_bf16 v[196:199], v[84:87], v[40:43], v[196:199]
  v_fma_f32 v14, v15, s37, v14
  v_cvt_pk_bf16_f32 v152, v14, v14
  v_mfma_f32_16x16x32_bf16 v[204:207], v[84:87], v[44:47], v[204:207]
  buffer_store_short v152, v6, s[12:15], 0 offen offset:1792 sc1
  v_mfma_f32_16x16x32_bf16 v[212:215], v[84:87], v[48:51], v[212:215]
  v_mfma_f32_16x16x32_bf16 v[220:223], v[84:87], v[52:55], v[220:223]
  s_waitcnt lgkmcnt(4)
  v_mfma_f32_16x16x32_bf16 v[160:163], v[88:91], v[20:23], v[160:163]
  ds_read_b64_tr_b16 v[84:85], v4 offset:2304
  ds_read_b64_tr_b16 v[86:87], v4 offset:2336
  v_mfma_f32_16x16x32_bf16 v[168:171], v[88:91], v[24:27], v[168:171]
  ds_read_u16_d16_hi v15, v5 offset:2048
  v_add_f32_dpp v11, v155, v158 wave_ror:1 row_mask:0xf bank_mask:0xf
  v_mfma_f32_16x16x32_bf16 v[176:179], v[88:91], v[28:31], v[176:179]
  v_add_f32_dpp v11, v159, v158 wave_shr:1 row_mask:0xf bank_mask:0xf
  v_add_f32_dpp v13, v10, v157 wave_ror:1 row_mask:0xf bank_mask:0xf
  v_mfma_f32_16x16x32_bf16 v[184:187], v[88:91], v[32:35], v[184:187]
  v_add_f32_dpp v13, v11, v157 wave_shr:1 row_mask:0xf bank_mask:0xf
  v_add_f32_dpp v14, v12, v156 wave_ror:1 row_mask:0xf bank_mask:0xf
  v_mfma_f32_16x16x32_bf16 v[192:195], v[88:91], v[36:39], v[192:195]
  v_add_f32_dpp v14, v13, v156 wave_shr:1 row_mask:0xf bank_mask:0xf
  s_waitcnt lgkmcnt(3)
  v_mfma_f32_16x16x32_bf16 v[200:203], v[88:91], v[40:43], v[200:203]
  v_fma_f32 v14, v16, s37, v14
  v_cvt_pk_bf16_f32 v156, v14, v14
  v_mfma_f32_16x16x32_bf16 v[208:211], v[88:91], v[44:47], v[208:211]
  buffer_store_short v156, v6, s[12:15], 0 offen offset:1920 sc1
  v_mfma_f32_16x16x32_bf16 v[216:219], v[88:91], v[48:51], v[216:219]
  s_waitcnt lgkmcnt(4)
  v_mfma_f32_16x16x32_bf16 v[164:167], v[92:95], v[20:23], v[164:167]
  ds_read_b64_tr_b16 v[88:89], v4 offset:2432
  ds_read_b64_tr_b16 v[90:91], v4 offset:2464
  v_mfma_f32_16x16x32_bf16 v[172:175], v[92:95], v[24:27], v[172:175]
  ds_read_u16_d16_hi v16, v5 offset:2176
  v_add_f32_dpp v10, v159, v162 wave_ror:1 row_mask:0xf bank_mask:0xf
  v_mfma_f32_16x16x32_bf16 v[180:183], v[92:95], v[28:31], v[180:183]
  v_add_f32_dpp v10, v163, v162 wave_shr:1 row_mask:0xf bank_mask:0xf
  v_add_f32_dpp v12, v11, v161 wave_ror:1 row_mask:0xf bank_mask:0xf
  v_mfma_f32_16x16x32_bf16 v[188:191], v[92:95], v[32:35], v[188:191]
  v_add_f32_dpp v12, v10, v161 wave_shr:1 row_mask:0xf bank_mask:0xf
  v_add_f32_dpp v14, v13, v160 wave_ror:1 row_mask:0xf bank_mask:0xf
  v_mfma_f32_16x16x32_bf16 v[196:199], v[92:95], v[36:39], v[196:199]
  v_add_f32_dpp v14, v12, v160 wave_shr:1 row_mask:0xf bank_mask:0xf
  s_waitcnt lgkmcnt(3)
  v_mfma_f32_16x16x32_bf16 v[204:207], v[92:95], v[40:43], v[204:207]
  v_fma_f32 v14, v15, s37, v14
  v_cvt_pk_bf16_f32 v160, v14, v14
  v_mfma_f32_16x16x32_bf16 v[212:215], v[92:95], v[44:47], v[212:215]
  buffer_store_short v160, v6, s[12:15], 0 offen offset:2048 sc1
  v_mfma_f32_16x16x32_bf16 v[220:223], v[92:95], v[48:51], v[220:223]
  s_waitcnt lgkmcnt(4)
  v_mfma_f32_16x16x32_bf16 v[168:171], v[84:87], v[20:23], v[168:171]
  ds_read_b64_tr_b16 v[92:93], v4 offset:2560
  ds_read_b64_tr_b16 v[94:95], v4 offset:2592
  v_mfma_f32_16x16x32_bf16 v[176:179], v[84:87], v[24:27], v[176:179]
  ds_read_u16_d16_hi v15, v5 offset:2304
  v_add_f32_dpp v11, v163, v166 wave_ror:1 row_mask:0xf bank_mask:0xf
  v_mfma_f32_16x16x32_bf16 v[184:187], v[84:87], v[28:31], v[184:187]
  v_add_f32_dpp v11, v167, v166 wave_shr:1 row_mask:0xf bank_mask:0xf
  v_add_f32_dpp v13, v10, v165 wave_ror:1 row_mask:0xf bank_mask:0xf
  v_mfma_f32_16x16x32_bf16 v[192:195], v[84:87], v[32:35], v[192:195]
  v_add_f32_dpp v13, v11, v165 wave_shr:1 row_mask:0xf bank_mask:0xf
  v_add_f32_dpp v14, v12, v164 wave_ror:1 row_mask:0xf bank_mask:0xf
  v_mfma_f32_16x16x32_bf16 v[200:203], v[84:87], v[36:39], v[200:203]
  v_add_f32_dpp v14, v13, v164 wave_shr:1 row_mask:0xf bank_mask:0xf
  s_waitcnt lgkmcnt(3)
  v_mfma_f32_16x16x32_bf16 v[208:211], v[84:87], v[40:43], v[208:211]
  v_fma_f32 v14, v16, s37, v14
  v_cvt_pk_bf16_f32 v164, v14, v14
  v_mfma_f32_16x16x32_bf16 v[216:219], v[84:87], v[44:47], v[216:219]
  buffer_store_short v164, v6, s[12:15], 0 offen offset:2176 sc1
  s_waitcnt lgkmcnt(4)
  v_mfma_f32_16x16x32_bf16 v[172:175], v[88:91], v[20:23], v[172:175]
  ds_read_b64_tr_b16 v[84:85], v4 offset:2688
  ds_read_b64_tr_b16 v[86:87], v4 offset:2720
  v_mfma_f32_16x16x32_bf16 v[180:183], v[88:91], v[24:27], v[180:183]
  ds_read_u16_d16_hi v16, v5 offset:2432
  v_add_f32_dpp v10, v167, v170 wave_ror:1 row_mask:0xf bank_mask:0xf
  v_mfma_f32_16x16x32_bf16 v[188:191], v[88:91], v[28:31], v[188:191]
  v_add_f32_dpp v10, v171, v170 wave_shr:1 row_mask:0xf bank_mask:0xf
  v_add_f32_dpp v12, v11, v169 wave_ror:1 row_mask:0xf bank_mask:0xf
  v_mfma_f32_16x16x32_bf16 v[196:199], v[88:91], v[32:35], v[196:199]
  v_add_f32_dpp v12, v10, v169 wave_shr:1 row_mask:0xf bank_mask:0xf
  v_add_f32_dpp v14, v13, v168 wave_ror:1 row_mask:0xf bank_mask:0xf
  v_mfma_f32_16x16x32_bf16 v[204:207], v[88:91], v[36:39], v[204:207]
  v_add_f32_dpp v14, v12, v168 wave_shr:1 row_mask:0xf bank_mask:0xf
  s_waitcnt lgkmcnt(3)
  v_mfma_f32_16x16x32_bf16 v[212:215], v[88:91], v[40:43], v[212:215]
  v_fma_f32 v14, v15, s37, v14
  v_cvt_pk_bf16_f32 v168, v14, v14
  v_mfma_f32_16x16x32_bf16 v[220:223], v[88:91], v[44:47], v[220:223]
  buffer_store_short v168, v6, s[12:15], 0 offen offset:2304 sc1
  s_waitcnt lgkmcnt(4)
  v_mfma_f32_16x16x32_bf16 v[176:179], v[92:95], v[20:23], v[176:179]
  ds_read_b64_tr_b16 v[88:89], v4 offset:2816
  ds_read_b64_tr_b16 v[90:91], v4 offset:2848
  v_mfma_f32_16x16x32_bf16 v[184:187], v[92:95], v[24:27], v[184:187]
  ds_read_u16_d16_hi v15, v5 offset:2560
  v_add_f32_dpp v11, v171, v174 wave_ror:1 row_mask:0xf bank_mask:0xf
  v_mfma_f32_16x16x32_bf16 v[192:195], v[92:95], v[28:31], v[192:195]
  v_add_f32_dpp v11, v175, v174 wave_shr:1 row_mask:0xf bank_mask:0xf
  v_add_f32_dpp v13, v10, v173 wave_ror:1 row_mask:0xf bank_mask:0xf
  v_mfma_f32_16x16x32_bf16 v[200:203], v[92:95], v[32:35], v[200:203]
  v_add_f32_dpp v13, v11, v173 wave_shr:1 row_mask:0xf bank_mask:0xf
  v_add_f32_dpp v14, v12, v172 wave_ror:1 row_mask:0xf bank_mask:0xf
  v_mfma_f32_16x16x32_bf16 v[208:211], v[92:95], v[36:39], v[208:211]
  v_add_f32_dpp v14, v13, v172 wave_shr:1 row_mask:0xf bank_mask:0xf
  s_waitcnt lgkmcnt(3)
  v_mfma_f32_16x16x32_bf16 v[216:219], v[92:95], v[40:43], v[216:219]
  v_fma_f32 v14, v16, s37, v14
  v_cvt_pk_bf16_f32 v172, v14, v14
  buffer_store_short v172, v6, s[12:15], 0 offen offset:2432 sc1
  s_waitcnt lgkmcnt(4)
  v_mfma_f32_16x16x32_bf16 v[180:183], v[84:87], v[20:23], v[180:183]
  ds_read_b64_tr_b16 v[92:93], v4 offset:2944
  ds_read_b64_tr_b16 v[94:95], v4 offset:2976
  v_mfma_f32_16x16x32_bf16 v[188:191], v[84:87], v[24:27], v[188:191]
  ds_read_u16_d16_hi v16, v5 offset:2688
  v_add_f32_dpp v10, v175, v178 wave_ror:1 row_mask:0xf bank_mask:0xf
  v_mfma_f32_16x16x32_bf16 v[196:199], v[84:87], v[28:31], v[196:199]
  v_add_f32_dpp v10, v179, v178 wave_shr:1 row_mask:0xf bank_mask:0xf
  v_add_f32_dpp v12, v11, v177 wave_ror:1 row_mask:0xf bank_mask:0xf
  v_mfma_f32_16x16x32_bf16 v[204:207], v[84:87], v[32:35], v[204:207]
  v_add_f32_dpp v12, v10, v177 wave_shr:1 row_mask:0xf bank_mask:0xf
  v_add_f32_dpp v14, v13, v176 wave_ror:1 row_mask:0xf bank_mask:0xf
  v_mfma_f32_16x16x32_bf16 v[212:215], v[84:87], v[36:39], v[212:215]
  v_add_f32_dpp v14, v12, v176 wave_shr:1 row_mask:0xf bank_mask:0xf
  s_waitcnt lgkmcnt(3)
  v_mfma_f32_16x16x32_bf16 v[220:223], v[84:87], v[40:43], v[220:223]
  v_fma_f32 v14, v15, s37, v14
  v_cvt_pk_bf16_f32 v176, v14, v14
  buffer_store_short v176, v6, s[12:15], 0 offen offset:2560 sc1
  s_waitcnt lgkmcnt(4)
  v_mfma_f32_16x16x32_bf16 v[184:187], v[88:91], v[20:23], v[184:187]
  ds_read_b64_tr_b16 v[84:85], v4 offset:3072
  ds_read_b64_tr_b16 v[86:87], v4 offset:3104
  v_mfma_f32_16x16x32_bf16 v[192:195], v[88:91], v[24:27], v[192:195]
  ds_read_u16_d16_hi v15, v5 offset:2816
  v_add_f32_dpp v11, v179, v182 wave_ror:1 row_mask:0xf bank_mask:0xf
  v_mfma_f32_16x16x32_bf16 v[200:203], v[88:91], v[28:31], v[200:203]
  v_add_f32_dpp v11, v183, v182 wave_shr:1 row_mask:0xf bank_mask:0xf
  v_add_f32_dpp v13, v10, v181 wave_ror:1 row_mask:0xf bank_mask:0xf
  v_mfma_f32_16x16x32_bf16 v[208:211], v[88:91], v[32:35], v[208:211]
  v_add_f32_dpp v13, v11, v181 wave_shr:1 row_mask:0xf bank_mask:0xf
  v_add_f32_dpp v14, v12, v180 wave_ror:1 row_mask:0xf bank_mask:0xf
  v_mfma_f32_16x16x32_bf16 v[216:219], v[88:91], v[36:39], v[216:219]
  v_add_f32_dpp v14, v13, v180 wave_shr:1 row_mask:0xf bank_mask:0xf
  s_waitcnt lgkmcnt(3)
  v_fma_f32 v14, v16, s37, v14
  v_cvt_pk_bf16_f32 v180, v14, v14
  buffer_store_short v180, v6, s[12:15], 0 offen offset:2688 sc1
  s_waitcnt lgkmcnt(4)
  v_mfma_f32_16x16x32_bf16 v[188:191], v[92:95], v[20:23], v[188:191]
  ds_read_b64_tr_b16 v[88:89], v4 offset:3200
  ds_read_b64_tr_b16 v[90:91], v4 offset:3232
  v_mfma_f32_16x16x32_bf16 v[196:199], v[92:95], v[24:27], v[196:199]
  ds_read_u16_d16_hi v16, v5 offset:2944
  v_add_f32_dpp v10, v183, v186 wave_ror:1 row_mask:0xf bank_mask:0xf
  v_mfma_f32_16x16x32_bf16 v[204:207], v[92:95], v[28:31], v[204:207]
  v_add_f32_dpp v10, v187, v186 wave_shr:1 row_mask:0xf bank_mask:0xf
  v_add_f32_dpp v12, v11, v185 wave_ror:1 row_mask:0xf bank_mask:0xf
  v_mfma_f32_16x16x32_bf16 v[212:215], v[92:95], v[32:35], v[212:215]
  v_add_f32_dpp v12, v10, v185 wave_shr:1 row_mask:0xf bank_mask:0xf
  v_add_f32_dpp v14, v13, v184 wave_ror:1 row_mask:0xf bank_mask:0xf
  v_mfma_f32_16x16x32_bf16 v[220:223], v[92:95], v[36:39], v[220:223]
  v_add_f32_dpp v14, v12, v184 wave_shr:1 row_mask:0xf bank_mask:0xf
  s_waitcnt lgkmcnt(3)
  v_fma_f32 v14, v15, s37, v14
  v_cvt_pk_bf16_f32 v184, v14, v14
  buffer_store_short v184, v6, s[12:15], 0 offen offset:2816 sc1
  s_waitcnt lgkmcnt(4)
  v_mfma_f32_16x16x32_bf16 v[192:195], v[84:87], v[20:23], v[192:195]
  ds_read_b64_tr_b16 v[92:93], v4 offset:3328
  ds_read_b64_tr_b16 v[94:95], v4 offset:3360
  v_mfma_f32_16x16x32_bf16 v[200:203], v[84:87], v[24:27], v[200:203]
  ds_read_u16_d16_hi v15, v5 offset:3072
  v_add_f32_dpp v11, v187, v190 wave_ror:1 row_mask:0xf bank_mask:0xf
  v_mfma_f32_16x16x32_bf16 v[208:211], v[84:87], v[28:31], v[208:211]
  v_add_f32_dpp v11, v191, v190 wave_shr:1 row_mask:0xf bank_mask:0xf
  v_add_f32_dpp v13, v10, v189 wave_ror:1 row_mask:0xf bank_mask:0xf
  v_mfma_f32_16x16x32_bf16 v[216:219], v[84:87], v[32:35], v[216:219]
  v_add_f32_dpp v13, v11, v189 wave_shr:1 row_mask:0xf bank_mask:0xf
  v_add_f32_dpp v14, v12, v188 wave_ror:1 row_mask:0xf bank_mask:0xf
  s_nop 0
  v_add_f32_dpp v14, v13, v188 wave_shr:1 row_mask:0xf bank_mask:0xf
  s_waitcnt lgkmcnt(3)
  v_fma_f32 v14, v16, s37, v14
  v_cvt_pk_bf16_f32 v188, v14, v14
  buffer_store_short v188, v6, s[12:15], 0 offen offset:2944 sc1
  s_waitcnt lgkmcnt(4)
  v_mfma_f32_16x16x32_bf16 v[196:199], v[88:91], v[20:23], v[196:199]
  ds_read_b64_tr_b16 v[84:85], v4 offset:3456
  ds_read_b64_tr_b16 v[86:87], v4 offset:3488
  v_mfma_f32_16x16x32_bf16 v[204:207], v[88:91], v[24:27], v[204:207]
  ds_read_u16_d16_hi v16, v5 offset:3200
  v_add_f32_dpp v10, v191, v194 wave_ror:1 row_mask:0xf bank_mask:0xf
  v_mfma_f32_16x16x32_bf16 v[212:215], v[88:91], v[28:31], v[212:215]
  v_add_f32_dpp v10, v195, v194 wave_shr:1 row_mask:0xf bank_mask:0xf
  v_add_f32_dpp v12, v11, v193 wave_ror:1 row_mask:0xf bank_mask:0xf
  v_mfma_f32_16x16x32_bf16 v[220:223], v[88:91], v[32:35], v[220:223]
  v_add_f32_dpp v12, v10, v193 wave_shr:1 row_mask:0xf bank_mask:0xf
  v_add_f32_dpp v14, v13, v192 wave_ror:1 row_mask:0xf bank_mask:0xf
  s_nop 0
  v_add_f32_dpp v14, v12, v192 wave_shr:1 row_mask:0xf bank_mask:0xf
  s_waitcnt lgkmcnt(3)
  v_fma_f32 v14, v15, s37, v14
  v_cvt_pk_bf16_f32 v192, v14, v14
  buffer_store_short v192, v6, s[12:15], 0 offen offset:3072 sc1
  s_waitcnt lgkmcnt(4)
  v_mfma_f32_16x16x32_bf16 v[200:203], v[92:95], v[20:23], v[200:203]
  ds_read_b64_tr_b16 v[88:89], v4 offset:3584
  ds_read_b64_tr_b16 v[90:91], v4 offset:3616
  v_mfma_f32_16x16x32_bf16 v[208:211], v[92:95], v[24:27], v[208:211]
  ds_read_u16_d16_hi v15, v5 offset:3328
  v_add_f32_dpp v11, v195, v198 wave_ror:1 row_mask:0xf bank_mask:0xf
  v_mfma_f32_16x16x32_bf16 v[216:219], v[92:95], v[28:31], v[216:219]
  v_add_f32_dpp v11, v199, v198 wave_shr:1 row_mask:0xf bank_mask:0xf
  v_add_f32_dpp v13, v10, v197 wave_ror:1 row_mask:0xf bank_mask:0xf
  s_nop 0
  v_add_f32_dpp v13, v11, v197 wave_shr:1 row_mask:0xf bank_mask:0xf
  v_add_f32_dpp v14, v12, v196 wave_ror:1 row_mask:0xf bank_mask:0xf
  s_nop 0
  v_add_f32_dpp v14, v13, v196 wave_shr:1 row_mask:0xf bank_mask:0xf
  s_waitcnt lgkmcnt(3)
  v_fma_f32 v14, v16, s37, v14
  v_cvt_pk_bf16_f32 v196, v14, v14
  buffer_store_short v196, v6, s[12:15], 0 offen offset:3200 sc1
  s_waitcnt lgkmcnt(4)
  v_mfma_f32_16x16x32_bf16 v[204:207], v[84:87], v[20:23], v[204:207]
  ds_read_b64_tr_b16 v[92:93], v4 offset:3712
  ds_read_b64_tr_b16 v[94:95], v4 offset:3744
  v_mfma_f32_16x16x32_bf16 v[212:215], v[84:87], v[24:27], v[212:215]
  ds_read_u16_d16_hi v16, v5 offset:3456
  v_add_f32_dpp v10, v199, v202 wave_ror:1 row_mask:0xf bank_mask:0xf
  v_mfma_f32_16x16x32_bf16 v[220:223], v[84:87], v[28:31], v[220:223]
  v_add_f32_dpp v10, v203, v202 wave_shr:1 row_mask:0xf bank_mask:0xf
  v_add_f32_dpp v12, v11, v201 wave_ror:1 row_mask:0xf bank_mask:0xf
  s_nop 0
  v_add_f32_dpp v12, v10, v201 wave_shr:1 row_mask:0xf bank_mask:0xf
  v_add_f32_dpp v14, v13, v200 wave_ror:1 row_mask:0xf bank_mask:0xf
  s_nop 0
  v_add_f32_dpp v14, v12, v200 wave_shr:1 row_mask:0xf bank_mask:0xf
  s_waitcnt lgkmcnt(3)
  v_fma_f32 v14, v15, s37, v14
  v_cvt_pk_bf16_f32 v200, v14, v14
  buffer_store_short v200, v6, s[12:15], 0 offen offset:3328 sc1
  s_waitcnt lgkmcnt(4)
  v_mfma_f32_16x16x32_bf16 v[208:211], v[88:91], v[20:23], v[208:211]
  ds_read_b64_tr_b16 v[84:85], v4 offset:3840
  ds_read_b64_tr_b16 v[86:87], v4 offset:3872
  v_mfma_f32_16x16x32_bf16 v[216:219], v[88:91], v[24:27], v[216:219]
  ds_read_u16_d16_hi v15, v5 offset:3584
  v_add_f32_dpp v11, v203, v206 wave_ror:1 row_mask:0xf bank_mask:0xf
  v_add_f32_dpp v11, v207, v206 wave_shr:1 row_mask:0xf bank_mask:0xf
  v_add_f32_dpp v13, v10, v205 wave_ror:1 row_mask:0xf bank_mask:0xf
  s_nop 0
  v_add_f32_dpp v13, v11, v205 wave_shr:1 row_mask:0xf bank_mask:0xf
  v_add_f32_dpp v14, v12, v204 wave_ror:1 row_mask:0xf bank_mask:0xf
  s_nop 0
  v_add_f32_dpp v14, v13, v204 wave_shr:1 row_mask:0xf bank_mask:0xf
  s_waitcnt lgkmcnt(3)
  v_fma_f32 v14, v16, s37, v14
  v_cvt_pk_bf16_f32 v204, v14, v14
  buffer_store_short v204, v6, s[12:15], 0 offen offset:3456 sc1
  s_waitcnt lgkmcnt(4)
  v_mfma_f32_16x16x32_bf16 v[212:215], v[92:95], v[20:23], v[212:215]
  ds_read_b64_tr_b16 v[88:89], v4 offset:3968
  ds_read_b64_tr_b16 v[90:91], v4 offset:4000
  v_mfma_f32_16x16x32_bf16 v[220:223], v[92:95], v[24:27], v[220:223]
  ds_read_u16_d16_hi v16, v5 offset:3712
  v_add_f32_dpp v10, v207, v210 wave_ror:1 row_mask:0xf bank_mask:0xf
  v_add_f32_dpp v10, v211, v210 wave_shr:1 row_mask:0xf bank_mask:0xf
  v_add_f32_dpp v12, v11, v209 wave_ror:1 row_mask:0xf bank_mask:0xf
  s_nop 0
  v_add_f32_dpp v12, v10, v209 wave_shr:1 row_mask:0xf bank_mask:0xf
  v_add_f32_dpp v14, v13, v208 wave_ror:1 row_mask:0xf bank_mask:0xf
  s_nop 0
  v_add_f32_dpp v14, v12, v208 wave_shr:1 row_mask:0xf bank_mask:0xf
  s_waitcnt lgkmcnt(3)
  v_fma_f32 v14, v15, s37, v14
  v_cvt_pk_bf16_f32 v208, v14, v14
  buffer_store_short v208, v6, s[12:15], 0 offen offset:3584 sc1
  s_waitcnt lgkmcnt(4)
  v_mfma_f32_16x16x32_bf16 v[216:219], v[84:87], v[20:23], v[216:219]
  ds_read_u16_d16_hi v15, v5 offset:3840
  v_add_f32_dpp v11, v211, v214 wave_ror:1 row_mask:0xf bank_mask:0xf
  v_add_f32_dpp v11, v215, v214 wave_shr:1 row_mask:0xf bank_mask:0xf
  v_add_f32_dpp v13, v10, v213 wave_ror:1 row_mask:0xf bank_mask:0xf
  s_nop 0
  v_add_f32_dpp v13, v11, v213 wave_shr:1 row_mask:0xf bank_mask:0xf
  v_add_f32_dpp v14, v12, v212 wave_ror:1 row_mask:0xf bank_mask:0xf
  s_nop 0
  v_add_f32_dpp v14, v13, v212 wave_shr:1 row_mask:0xf bank_mask:0xf
  s_waitcnt lgkmcnt(1)
  v_fma_f32 v14, v16, s37, v14
  v_cvt_pk_bf16_f32 v212, v14, v14
  buffer_store_short v212, v6, s[12:15], 0 offen offset:3712 sc1
  s_waitcnt lgkmcnt(2)
  v_mfma_f32_16x16x32_bf16 v[220:223], v[88:91], v[20:23], v[220:223]
  ds_read_u16_d16_hi v16, v5 offset:3968
  v_add_f32_dpp v10, v215, v218 wave_ror:1 row_mask:0xf bank_mask:0xf
  v_add_f32_dpp v10, v219, v218 wave_shr:1 row_mask:0xf bank_mask:0xf
  v_add_f32_dpp v12, v11, v217 wave_ror:1 row_mask:0xf bank_mask:0xf
  s_nop 0
  v_add_f32_dpp v12, v10, v217 wave_shr:1 row_mask:0xf bank_mask:0xf
  v_add_f32_dpp v14, v13, v216 wave_ror:1 row_mask:0xf bank_mask:0xf
  s_nop 0
  v_add_f32_dpp v14, v12, v216 wave_shr:1 row_mask:0xf bank_mask:0xf
  s_waitcnt lgkmcnt(1)
  v_fma_f32 v14, v15, s37, v14
  v_cvt_pk_bf16_f32 v216, v14, v14
  buffer_store_short v216, v6, s[12:15], 0 offen offset:3840 sc1
  s_nop 7
  v_add_f32_dpp v11, v219, v222 wave_ror:1 row_mask:0xf bank_mask:0xf
  v_add_f32_dpp v11, v223, v222 wave_shr:1 row_mask:0xf bank_mask:0xf
  v_add_f32_dpp v13, v10, v221 wave_ror:1 row_mask:0xf bank_mask:0xf
  s_nop 0
  v_add_f32_dpp v13, v11, v221 wave_shr:1 row_mask:0xf bank_mask:0xf
  v_add_f32_dpp v14, v12, v220 wave_ror:1 row_mask:0xf bank_mask:0xf
  s_nop 0
  v_add_f32_dpp v14, v13, v220 wave_shr:1 row_mask:0xf bank_mask:0xf
  s_waitcnt lgkmcnt(0)
  v_fma_f32 v14, v16, s37, v14
  v_cvt_pk_bf16_f32 v220, v14, v14
  buffer_store_short v220, v6, s[12:15], 0 offen offset:3968 sc1
  s_branch cv_end
cv_tm:
  ds_read_b64_tr_b16 v[84:85], v4 offset:0
  ds_read_b64_tr_b16 v[86:87], v4 offset:32
  ds_read_b64_tr_b16 v[88:89], v4 offset:128
  ds_read_b64_tr_b16 v[90:91], v4 offset:160
  s_waitcnt lgkmcnt(2)
  v_mfma_f32_16x16x32_bf16 v[212:215], v[84:87], v[20:23], 0
  ds_read_b64_tr_b16 v[92:93], v4 offset:256
  ds_read_b64_tr_b16 v[94:95], v4 offset:288
  ds_read_u16_d16_hi v15, v5 offset:0
  s_waitcnt lgkmcnt(3)
  v_mfma_f32_16x16x32_bf16 v[216:219], v[88:91], v[20:23], 0
  ds_read_b64_tr_b16 v[96:97], v4 offset:384
  ds_read_b64_tr_b16 v[98:99], v4 offset:416
  ds_read_u16_d16_hi v16, v5 offset:128
  s_nop 0
  v_add_f32_dpp v10, v18, v214 wave_ror:1 row_mask:0xf bank_mask:0xf
  v_add_f32_dpp v10, v215, v214 wave_shr:1 row_mask:0xf bank_mask:0xf
  v_add_f32_dpp v12, v18, v213 wave_ror:1 row_mask:0xf bank_mask:0xf
  s_nop 0
  v_add_f32_dpp v12, v10, v213 wave_shr:1 row_mask:0xf bank_mask:0xf
  v_add_f32_dpp v14, v18, v212 wave_ror:1 row_mask:0xf bank_mask:0xf
  s_nop 0
  v_add_f32_dpp v14, v12, v212 wave_shr:1 row_mask:0xf bank_mask:0xf
  s_waitcnt lgkmcnt(3)
  v_fma_f32 v14, v15, s37, v14
  v_cvt_pk_bf16_f32 v212, v14, v14
  buffer_store_short v212, v6, s[12:15], 0 offen offset:0 sc1
  s_waitcnt lgkmcnt(4)
  v_mfma_f32_16x16x32_bf16 v[220:223], v[84:87], v[24:27], 0
  ds_read_b64_tr_b16 v[100:101], v4 offset:512
  ds_read_b64_tr_b16 v[102:103], v4 offset:544
  v_mfma_f32_16x16x32_bf16 v[220:223], v[92:95], v[20:23], v[220:223]
  ds_read_u16_d16_hi v15, v5 offset:256
  v_add_f32_dpp v11, v215, v218 wave_ror:1 row_mask:0xf bank_mask:0xf
  v_add_f32_dpp v11, v219, v218 wave_shr:1 row_mask:0xf bank_mask:0xf
  v_add_f32_dpp v13, v10, v217 wave_ror:1 row_mask:0xf bank_mask:0xf
  s_nop 0
  v_add_f32_dpp v13, v11, v217 wave_shr:1 row_mask:0xf bank_mask:0xf
  v_add_f32_dpp v14, v12, v216 wave_ror:1 row_mask:0xf bank_mask:0xf
  s_nop 0
  v_add_f32_dpp v14, v13, v216 wave_shr:1 row_mask:0xf bank_mask:0xf
  s_waitcnt lgkmcnt(3)
  v_fma_f32 v14, v16, s37, v14
  v_cvt_pk_bf16_f32 v216, v14, v14
  buffer_store_short v216, v6, s[12:15], 0 offen offset:128 sc1
  s_waitcnt lgkmcnt(4)
  v_mfma_f32_16x16x32_bf16 v[212:215], v[88:91], v[24:27], 0
  ds_read_b64_tr_b16 v[104:105], v4 offset:640
  ds_read_b64_tr_b16 v[106:107], v4 offset:672
  v_mfma_f32_16x16x32_bf16 v[212:215], v[96:99], v[20:23], v[212:215]
  ds_read_u16_d16_hi v16, v5 offset:384
  v_add_f32_dpp v10, v219, v222 wave_ror:1 row_mask:0xf bank_mask:0xf
  v_add_f32_dpp v10, v223, v222 wave_shr:1 row_mask:0xf bank_mask:0xf
  v_add_f32_dpp v12, v11, v221 wave_ror:1 row_mask:0xf bank_mask:0xf
  s_nop 0
  v_add_f32_dpp v12, v10, v221 wave_shr:1 row_mask:0xf bank_mask:0xf
  v_add_f32_dpp v14, v13, v220 wave_ror:1 row_mask:0xf bank_mask:0xf
  s_nop 0
  v_add_f32_dpp v14, v12, v220 wave_shr:1 row_mask:0xf bank_mask:0xf
  s_waitcnt lgkmcnt(3)
  v_fma_f32 v14, v15, s37, v14
  v_cvt_pk_bf16_f32 v220, v14, v14
  buffer_store_short v220, v6, s[12:15], 0 offen offset:256 sc1
  s_waitcnt lgkmcnt(4)
  v_mfma_f32_16x16x32_bf16 v[216:219], v[84:87], v[28:31], 0
  ds_read_b64_tr_b16 v[108:109], v4 offset:768
  ds_read_b64_tr_b16 v[110:111], v4 offset:800
  v_mfma_f32_16x16x32_bf16 v[216:219], v[92:95], v[24:27], v[216:219]
  ds_read_u16_d16_hi v15, v5 offset:512
  v_add_f32_dpp v11, v223, v214 wave_ror:1 row_mask:0xf bank_mask:0xf
  v_mfma_f32_16x16x32_bf16 v[216:219], v[100:103], v[20:23], v[216:219]
  v_add_f32_dpp v11, v215, v214 wave_shr:1 row_mask:0xf bank_mask:0xf
  v_add_f32_dpp v13, v10, v213 wave_ror:1 row_mask:0xf bank_mask:0xf
  s_nop 0
  v_add_f32_dpp v13, v11, v213 wave_shr:1 row_mask:0xf bank_mask:0xf
  v_add_f32_dpp v14, v12, v212 wave_ror:1 row_mask:0xf bank_mask:0xf
  s_nop 0
  v_add_f32_dpp v14, v13, v212 wave_shr:1 row_mask:0xf bank_mask:0xf
  s_waitcnt lgkmcnt(3)
  v_fma_f32 v14, v16, s37, v14
  v_cvt_pk_bf16_f32 v212, v14, v14
  buffer_store_short v212, v6, s[12:15], 0 offen offset:384 sc1
  s_waitcnt lgkmcnt(4)
  v_mfma_f32_16x16x32_bf16 v[220:223], v[88:91], v[28:31], 0
  ds_read_b64_tr_b16 v[112:113], v4 offset:896
  ds_read_b64_tr_b16 v[114:115], v4 offset:928
  v_mfma_f32_16x16x32_bf16 v[220:223], v[96:99], v[24:27], v[220:223]
  ds_read_u16_d16_hi v16, v5 offset:640
  v_add_f32_dpp v10, v215, v218 wave_ror:1 row_mask:0xf bank_mask:0xf
  v_mfma_f32_16x16x32_bf16 v[220:223], v[104:107], v[20:23], v[220:223]
  v_add_f32_dpp v10, v219, v218 wave_shr:1 row_mask:0xf bank_mask:0xf
  v_add_f32_dpp v12, v11, v217 wave_ror:1 row_mask:0xf bank_mask:0xf
  s_nop 0
  v_add_f32_dpp v12, v10, v217 wave_shr:1 row_mask:0xf bank_mask:0xf
  v_add_f32_dpp v14, v13, v216 wave_ror:1 row_mask:0xf bank_mask:0xf
  s_nop 0
  v_add_f32_dpp v14, v12, v216 wave_shr:1 row_mask:0xf bank_mask:0xf
  s_waitcnt lgkmcnt(3)
  v_fma_f32 v14, v15, s37, v14
  v_cvt_pk_bf16_f32 v216, v14, v14
  buffer_store_short v216, v6, s[12:15], 0 offen offset:512 sc1
  s_waitcnt lgkmcnt(4)
  v_mfma_f32_16x16x32_bf16 v[212:215], v[84:87], v[32:35], 0
  ds_read_b64_tr_b16 v[116:117], v4 offset:1024
  ds_read_b64_tr_b16 v[118:119], v4 offset:1056
  v_mfma_f32_16x16x32_bf16 v[212:215], v[92:95], v[28:31], v[212:215]
  ds_read_u16_d16_hi v15, v5 offset:768
  v_add_f32_dpp v11, v219, v222 wave_ror:1 row_mask:0xf bank_mask:0xf
  v_mfma_f32_16x16x32_bf16 v[212:215], v[100:103], v[24:27], v[212:215]
  v_add_f32_dpp v11, v223, v222 wave_shr:1 row_mask:0xf bank_mask:0xf
  v_add_f32_dpp v13, v10, v221 wave_ror:1 row_mask:0xf bank_mask:0xf
  v_mfma_f32_16x16x32_bf16 v[212:215], v[108:111], v[20:23], v[212:215]
  v_add_f32_dpp v13, v11, v221 wave_shr:1 row_mask:0xf bank_mask:0xf
  v_add_f32_dpp v14, v12, v220 wave_ror:1 row_mask:0xf bank_mask:0xf
  s_nop 0
  v_add_f32_dpp v14, v13, v220 wave_shr:1 row_mask:0xf bank_mask:0xf
  s_waitcnt lgkmcnt(3)
  v_fma_f32 v14, v16, s37, v14
  v_cvt_pk_bf16_f32 v220, v14, v14
  buffer_store_short v220, v6, s[12:15], 0 offen offset:640 sc1
  s_waitcnt lgkmcnt(4)
  v_mfma_f32_16x16x32_bf16 v[216:219], v[88:91], v[32:35], 0
  ds_read_b64_tr_b16 v[120:121], v4 offset:1152
  ds_read_b64_tr_b16 v[122:123], v4 offset:1184
  v_mfma_f32_16x16x32_bf16 v[216:219], v[96:99], v[28:31], v[216:219]
  ds_read_u16_d16_hi v16, v5 offset:896
  v_add_f32_dpp v10, v223, v214 wave_ror:1 row_mask:0xf bank_mask:0xf
  v_mfma_f32_16x16x32_bf16 v[216:219], v[104:107], v[24:27], v[216:219]
  v_add_f32_dpp v10, v215, v214 wave_shr:1 row_mask:0xf bank_mask:0xf
  v_add_f32_dpp v12, v11, v213 wave_ror:1 row_mask:0xf bank_mask:0xf
  v_mfma_f32_16x16x32_bf16 v[216:219], v[112:115], v[20:23], v[216:219]
  v_add_f32_dpp v12, v10, v213 wave_shr:1 row_mask:0xf bank_mask:0xf
  v_add_f32_dpp v14, v13, v212 wave_ror:1 row_mask:0xf bank_mask:0xf
  s_nop 0
  v_add_f32_dpp v14, v12, v212 wave_shr:1 row_mask:0xf bank_mask:0xf
  s_waitcnt lgkmcnt(3)
  v_fma_f32 v14, v15, s37, v14
  v_cvt_pk_bf16_f32 v212, v14, v14
  buffer_store_short v212, v6, s[12:15], 0 offen offset:768 sc1
  s_waitcnt lgkmcnt(4)
  v_mfma_f32_16x16x32_bf16 v[220:223], v[84:87], v[36:39], 0
  ds_read_b64_tr_b16 v[124:125], v4 offset:1280
  ds_read_b64_tr_b16 v[126:127], v4 offset:1312
  v_mfma_f32_16x16x32_bf16 v[220:223], v[92:95], v[32:35], v[220:223]
  ds_read_u16_d16_hi v15, v5 offset:1024
  v_add_f32_dpp v11, v215, v218 wave_ror:1 row_mask:0xf bank_mask:0xf
  v_mfma_f32_16x16x32_bf16 v[220:223], v[100:103], v[28:31], v[220:223]
  v_add_f32_dpp v11, v219, v218 wave_shr:1 row_mask:0xf bank_mask:0xf
  v_add_f32_dpp v13, v10, v217 wave_ror:1 row_mask:0xf bank_mask:0xf
  v_mfma_f32_16x16x32_bf16 v[220:223], v[108:111], v[24:27], v[220:223]
  v_add_f32_dpp v13, v11, v217 wave_shr:1 row_mask:0xf bank_mask:0xf
  v_add_f32_dpp v14, v12, v216 wave_ror:1 row_mask:0xf bank_mask:0xf
  v_mfma_f32_16x16x32_bf16 v[220:223], v[116:119], v[20:23], v[220:223]
  v_add_f32_dpp v14, v13, v216 wave_shr:1 row_mask:0xf bank_mask:0xf
  s_waitcnt lgkmcnt(3)
  v_fma_f32 v14, v16, s37, v14
  v_cvt_pk_bf16_f32 v216, v14, v14
  buffer_store_short v216, v6, s[12:15], 0 offen offset:896 sc1
  s_waitcnt lgkmcnt(4)
  v_mfma_f32_16x16x32_bf16 v[212:215], v[88:91], v[36:39], 0
  ds_read_b64_tr_b16 v[128:129], v4 offset:1408
  ds_read_b64_tr_b16 v[130:131], v4 offset:1440
  v_mfma_f32_16x16x32_bf16 v[212:215], v[96:99], v[32:35], v[212:215]
  ds_read_u16_d16_hi v16, v5 offset:1152
  v_add_f32_dpp v10, v219, v222 wave_ror:1 row_mask:0xf bank_mask:0xf
  v_mfma_f32_16x16x32_bf16 v[212:215], v[104:107], v[28:31], v[212:215]
  v_add_f32_dpp v10, v223, v222 wave_shr:1 row_mask:0xf bank_mask:0xf
  v_add_f32_dpp v12, v11, v221 wave_ror:1 row_mask:0xf bank_mask:0xf
  v_mfma_f32_16x16x32_bf16 v[212:215], v[112:115], v[24:27], v[212:215]
  v_add_f32_dpp v12, v10, v221 wave_shr:1 row_mask:0xf bank_mask:0xf
  v_add_f32_dpp v14, v13, v220 wave_ror:1 row_mask:0xf bank_mask:0xf
  v_mfma_f32_16x16x32_bf16 v[212:215], v[120:123], v[20:23], v[212:215]
  v_add_f32_dpp v14, v12, v220 wave_shr:1 row_mask:0xf bank_mask:0xf
  s_waitcnt lgkmcnt(3)
  v_fma_f32 v14, v15, s37, v14
  v_cvt_pk_bf16_f32 v220, v14, v14
  buffer_store_short v220, v6, s[12:15], 0 offen offset:1024 sc1
  s_waitcnt lgkmcnt(4)
  v_mfma_f32_16x16x32_bf16 v[216:219], v[84:87], v[40:43], 0
  ds_read_b64_tr_b16 v[132:133], v4 offset:1536
  ds_read_b64_tr_b16 v[134:135], v4 offset:1568
  v_mfma_f32_16x16x32_bf16 v[216:219], v[92:95], v[36:39], v[216:219]
  ds_read_u16_d16_hi v15, v5 offset:1280
  v_add_f32_dpp v11, v223, v214 wave_ror:1 row_mask:0xf bank_mask:0xf
  v_mfma_f32_16x16x32_bf16 v[216:219], v[100:103], v[32:35], v[216:219]
  v_add_f32_dpp v11, v215, v214 wave_shr:1 row_mask:0xf bank_mask:0xf
  v_add_f32_dpp v13, v10, v213 wave_ror:1 row_mask:0xf bank_mask:0xf
  v_mfma_f32_16x16x32_bf16 v[216:219], v[108:111], v[28:31], v[216:219]
  v_add_f32_dpp v13, v11, v213 wave_shr:1 row_mask:0xf bank_mask:0xf
  v_add_f32_dpp v14, v12, v212 wave_ror:1 row_mask:0xf bank_mask:0xf
  v_mfma_f32_16x16x32_bf16 v[216:219], v[116:119], v[24:27], v[216:219]
  v_add_f32_dpp v14, v13, v212 wave_shr:1 row_mask:0xf bank_mask:0xf
  s_waitcnt lgkmcnt(3)
  v_mfma_f32_16x16x32_bf16 v[216:219], v[124:127], v[20:23], v[216:219]
  v_fma_f32 v14, v16, s37, v14
  v_cvt_pk_bf16_f32 v212, v14, v14
  buffer_store_short v212, v6, s[12:15], 0 offen offset:1152 sc1
  s_waitcnt lgkmcnt(4)
  v_mfma_f32_16x16x32_bf16 v[220:223], v[88:91], v[40:43], 0
  ds_read_b64_tr_b16 v[136:137], v4 offset:1664
  ds_read_b64_tr_b16 v[138:139], v4 offset:1696
  v_mfma_f32_16x16x32_bf16 v[220:223], v[96:99], v[36:39], v[220:223]
  ds_read_u16_d16_hi v16, v5 offset:1408
  v_add_f32_dpp v10, v215, v218 wave_ror:1 row_mask:0xf bank_mask:0xf
  v_mfma_f32_16x16x32_bf16 v[220:223], v[104:107], v[32:35], v[220:223]
  v_add_f32_dpp v10, v219, v218 wave_shr:1 row_mask:0xf bank_mask:0xf
  v_add_f32_dpp v12, v11, v217 wave_ror:1 row_mask:0xf bank_mask:0xf
  v_mfma_f32_16x16x32_bf16 v[220:223], v[112:115], v[28:31], v[220:223]
  v_add_f32_dpp v12, v10, v217 wave_shr:1 row_mask:0xf bank_mask:0xf
  v_add_f32_dpp v14, v13, v216 wave_ror:1 row_mask:0xf bank_mask:0xf
  v_mfma_f32_16x16x32_bf16 v[220:223], v[120:123], v[24:27], v[220:223]
  v_add_f32_dpp v14, v12, v216 wave_shr:1 row_mask:0xf bank_mask:0xf
  s_waitcnt lgkmcnt(3)
  v_mfma_f32_16x16x32_bf16 v[220:223], v[128:131], v[20:23], v[220:223]
  v_fma_f32 v14, v15, s37, v14
  v_cvt_pk_bf16_f32 v216, v14, v14
  buffer_store_short v216, v6, s[12:15], 0 offen offset:1280 sc1
  s_waitcnt lgkmcnt(4)
  v_mfma_f32_16x16x32_bf16 v[212:215], v[84:87], v[44:47], 0
  ds_read_b64_tr_b16 v[140:141], v4 offset:1792
  ds_read_b64_tr_b16 v[142:143], v4 offset:1824
  v_mfma_f32_16x16x32_bf16 v[212:215], v[92:95], v[40:43], v[212:215]
  ds_read_u16_d16_hi v15, v5 offset:1536
  v_add_f32_dpp v11, v219, v222 wave_ror:1 row_mask:0xf bank_mask:0xf
  v_mfma_f32_16x16x32_bf16 v[212:215], v[100:103], v[36:39], v[212:215]
  v_add_f32_dpp v11, v223, v222 wave_shr:1 row_mask:0xf bank_mask:0xf
  v_add_f32_dpp v13, v10, v221 wave_ror:1 row_mask:0xf bank_mask:0xf
  v_mfma_f32_16x16x32_bf16 v[212:215], v[108:111], v[32:35], v[212:215]
  v_add_f32_dpp v13, v11, v221 wave_shr:1 row_mask:0xf bank_mask:0xf
  v_add_f32_dpp v14, v12, v220 wave_ror:1 row_mask:0xf bank_mask:0xf
  v_mfma_f32_16x16x32_bf16 v[212:215], v[116:119], v[28:31], v[212:215]
  v_add_f32_dpp v14, v13, v220 wave_shr:1 row_mask:0xf bank_mask:0xf
  s_waitcnt lgkmcnt(3)
  v_mfma_f32_16x16x32_bf16 v[212:215], v[124:127], v[24:27], v[212:215]
  v_fma_f32 v14, v16, s37, v14
  v_cvt_pk_bf16_f32 v220, v14, v14
  v_mfma_f32_16x16x32_bf16 v[212:215], v[132:135], v[20:23], v[212:215]
  buffer_store_short v220, v6, s[12:15], 0 offen offset:1408 sc1
  s_waitcnt lgkmcnt(4)
  v_mfma_f32_16x16x32_bf16 v[216:219], v[88:91], v[44:47], 0
  ds_read_b64_tr_b16 v[144:145], v4 offset:1920
  ds_read_b64_tr_b16 v[146:147], v4 offset:1952
  v_mfma_f32_16x16x32_bf16 v[216:219], v[96:99], v[40:43], v[216:219]
  ds_read_u16_d16_hi v16, v5 offset:1664
  v_mfma_f32_16x16x32_bf16 v[216:219], v[104:107], v[36:39], v[216:219]
  v_mfma_f32_16x16x32_bf16 v[216:219], v[112:115], v[32:35], v[216:219]
  v_add_f32_dpp v10, v223, v214 wave_ror:1 row_mask:0xf bank_mask:0xf
  v_add_f32_dpp v10, v215, v214 wave_shr:1 row_mask:0xf bank_mask:0xf
  v_mfma_f32_16x16x32_bf16 v[216:219], v[120:123], v[28:31], v[216:219]
  v_add_f32_dpp v12, v11, v213 wave_ror:1 row_mask:0xf bank_mask:0xf
  v_mfma_f32_16x16x32_bf16 v[216:219], v[128:131], v[24:27], v[216:219]
  v_add_f32_dpp v12, v10, v213 wave_shr:1 row_mask:0xf bank_mask:0xf
  v_add_f32_dpp v14, v13, v212 wave_ror:1 row_mask:0xf bank_mask:0xf
  v_mfma_f32_16x16x32_bf16 v[216:219], v[136:139], v[20:23], v[216:219]
  v_add_f32_dpp v14, v12, v212 wave_shr:1 row_mask:0xf bank_mask:0xf
  s_waitcnt lgkmcnt(3)
  v_fma_f32 v14, v15, s37, v14
  v_cvt_pk_bf16_f32 v212, v14, v14
  buffer_store_short v212, v6, s[12:15], 0 offen offset:1536 sc1
  s_waitcnt lgkmcnt(4)
  v_mfma_f32_16x16x32_bf16 v[220:223], v[84:87], v[48:51], 0
  ds_read_b64_tr_b16 v[148:149], v4 offset:2048
  ds_read_b64_tr_b16 v[150:151], v4 offset:2080
  v_mfma_f32_16x16x32_bf16 v[220:223], v[92:95], v[44:47], v[220:223]
  ds_read_u16_d16_hi v15, v5 offset:1792
  v_add_f32_dpp v11, v215, v218 wave_ror:1 row_mask:0xf bank_mask:0xf
  v_mfma_f32_16x16x32_bf16 v[220:223], v[100:103], v[40:43], v[220:223]
  v_add_f32_dpp v11, v219, v218 wave_shr:1 row_mask:0xf bank_mask:0xf
  v_add_f32_dpp v13, v10, v217 wave_ror:1 row_mask:0xf bank_mask:0xf
  v_mfma_f32_16x16x32_bf16 v[220:223], v[108:111], v[36:39], v[220:223]
  v_add_f32_dpp v13, v11, v217 wave_shr:1 row_mask:0xf bank_mask:0xf
  v_add_f32_dpp v14, v12, v216 wave_ror:1 row_mask:0xf bank_mask:0xf
  v_mfma_f32_16x16x32_bf16 v[220:223], v[116:119], v[32:35], v[220:223]
  v_add_f32_dpp v14, v13, v216 wave_shr:1 row_mask:0xf bank_mask:0xf
  s_waitcnt lgkmcnt(3)
  v_mfma_f32_16x16x32_bf16 v[220:223], v[124:127], v[28:31], v[220:223]
  v_fma_f32 v14, v16, s37, v14
  v_cvt_pk_bf16_f32 v216, v14, v14
  v_mfma_f32_16x16x32_bf16 v[220:223], v[132:135], v[24:27], v[220:223]
  buffer_store_short v216, v6, s[12:15], 0 offen offset:1664 sc1
  v_mfma_f32_16x16x32_bf16 v[220:223], v[140:143], v[20:23], v[220:223]
  s_waitcnt lgkmcnt(4)
  v_mfma_f32_16x16x32_bf16 v[212:215], v[88:91], v[48:51], 0
  ds_read_b64_tr_b16 v[152:153], v4 offset:2176
  ds_read_b64_tr_b16 v[154:155], v4 offset:2208
  v_mfma_f32_16x16x32_bf16 v[212:215], v[96:99], v[44:47], v[212:215]
  ds_read_u16_d16_hi v16, v5 offset:1920
  v_mfma_f32_16x16x32_bf16 v[212:215], v[104:107], v[40:43], v[212:215]
  v_mfma_f32_16x16x32_bf16 v[212:215], v[112:115], v[36:39], v[212:215]
  v_mfma_f32_16x16x32_bf16 v[212:215], v[120:123], v[32:35], v[212:215]
  v_add_f32_dpp v10, v219, v222 wave_ror:1 row_mask:0xf bank_mask:0xf
  v_add_f32_dpp v10, v223, v222 wave_shr:1 row_mask:0xf bank_mask:0xf
  v_mfma_f32_16x16x32_bf16 v[212:215], v[128:131], v[28:31], v[212:215]
  v_add_f32_dpp v12, v11, v221 wave_ror:1 row_mask:0xf bank_mask:0xf
  v_mfma_f32_16x16x32_bf16 v[212:215], v[136:139], v[24:27], v[212:215]
  v_add_f32_dpp v12, v10, v221 wave_shr:1 row_mask:0xf bank_mask:0xf
  v_add_f32_dpp v14, v13, v220 wave_ror:1 row_mask:0xf bank_mask:0xf
  v_mfma_f32_16x16x32_bf16 v[212:215], v[144:147], v[20:23], v[212:215]
  v_add_f32_dpp v14, v12, v220 wave_shr:1 row_mask:0xf bank_mask:0xf
  s_waitcnt lgkmcnt(3)
  v_fma_f32 v14, v15, s37, v14
  v_cvt_pk_bf16_f32 v220, v14, v14
  buffer_store_short v220, v6, s[12:15], 0 offen offset:1792 sc1
  s_waitcnt lgkmcnt(4)
  v_mfma_f32_16x16x32_bf16 v[216:219], v[84:87], v[52:55], 0
  ds_read_b64_tr_b16 v[156:157], v4 offset:2304
  ds_read_b64_tr_b16 v[158:159], v4 offset:2336
  v_mfma_f32_16x16x32_bf16 v[216:219], v[92:95], v[48:51], v[216:219]
  ds_read_u16_d16_hi v15, v5 offset:2048
  v_add_f32_dpp v11, v223, v214 wave_ror:1 row_mask:0xf bank_mask:0xf
  v_mfma_f32_16x16x32_bf16 v[216:219], v[100:103], v[44:47], v[216:219]
  v_add_f32_dpp v11, v215, v214 wave_shr:1 row_mask:0xf bank_mask:0xf
  v_add_f32_dpp v13, v10, v213 wave_ror:1 row_mask:0xf bank_mask:0xf
  v_mfma_f32_16x16x32_bf16 v[216:219], v[108:111], v[40:43], v[216:219]
  v_add_f32_dpp v13, v11, v213 wave_shr:1 row_mask:0xf bank_mask:0xf
  v_add_f32_dpp v14, v12, v212 wave_ror:1 row_mask:0xf bank_mask:0xf
  v_mfma_f32_16x16x32_bf16 v[216:219], v[116:119], v[36:39], v[216:219]
  v_add_f32_dpp v14, v13, v212 wave_shr:1 row_mask:0xf bank_mask:0xf
  s_waitcnt lgkmcnt(3)
  v_mfma_f32_16x16x32_bf16 v[216:219], v[124:127], v[32:35], v[216:219]
  v_fma_f32 v14, v16, s37, v14
  v_cvt_pk_bf16_f32 v212, v14, v14
  v_mfma_f32_16x16x32_bf16 v[216:219], v[132:135], v[28:31], v[216:219]
  buffer_store_short v212, v6, s[12:15], 0 offen offset:1920 sc1
  v_mfma_f32_16x16x32_bf16 v[216:219], v[140:143], v[24:27], v[216:219]
  v_mfma_f32_16x16x32_bf16 v[216:219], v[148:151], v[20:23], v[216:219]
  s_waitcnt lgkmcnt(4)
  v_mfma_f32_16x16x32_bf16 v[220:223], v[88:91], v[52:55], 0
  ds_read_b64_tr_b16 v[160:161], v4 offset:2432
  ds_read_b64_tr_b16 v[162:163], v4 offset:2464
  v_mfma_f32_16x16x32_bf16 v[220:223], v[96:99], v[48:51], v[220:223]
  ds_read_u16_d16_hi v16, v5 offset:2176
  v_mfma_f32_16x16x32_bf16 v[220:223], v[104:107], v[44:47], v[220:223]
  v_mfma_f32_16x16x32_bf16 v[220:223], v[112:115], v[40:43], v[220:223]
  v_mfma_f32_16x16x32_bf16 v[220:223], v[120:123], v[36:39], v[220:223]
  v_add_f32_dpp v10, v215, v218 wave_ror:1 row_mask:0xf bank_mask:0xf
  v_add_f32_dpp v10, v219, v218 wave_shr:1 row_mask:0xf bank_mask:0xf
  v_mfma_f32_16x16x32_bf16 v[220:223], v[128:131], v[32:35], v[220:223]
  v_add_f32_dpp v12, v11, v217 wave_ror:1 row_mask:0xf bank_mask:0xf
  v_mfma_f32_16x16x32_bf16 v[220:223], v[136:139], v[28:31], v[220:223]
  v_add_f32_dpp v12, v10, v217 wave_shr:1 row_mask:0xf bank_mask:0xf
  v_add_f32_dpp v14, v13, v216 wave_ror:1 row_mask:0xf bank_mask:0xf
  v_mfma_f32_16x16x32_bf16 v[220:223], v[144:147], v[24:27], v[220:223]
  v_add_f32_dpp v14, v12, v216 wave_shr:1 row_mask:0xf bank_mask:0xf
  s_waitcnt lgkmcnt(3)
  v_mfma_f32_16x16x32_bf16 v[220:223], v[152:155], v[20:23], v[220:223]
  v_fma_f32 v14, v15, s37, v14
  v_cvt_pk_bf16_f32 v216, v14, v14
  buffer_store_short v216, v6, s[12:15], 0 offen offset:2048 sc1
  s_waitcnt lgkmcnt(4)
  v_mfma_f32_16x16x32_bf16 v[212:215], v[84:87], v[56:59], 0
  ds_read_b64_tr_b16 v[164:165], v4 offset:2560
  ds_read_b64_tr_b16 v[166:167], v4 offset:2592
  v_mfma_f32_16x16x32_bf16 v[212:215], v[92:95], v[52:55], v[212:215]
  ds_read_u16_d16_hi v15, v5 offset:2304
  v_add_f32_dpp v11, v219, v222 wave_ror:1 row_mask:0xf bank_mask:0xf
  v_mfma_f32_16x16x32_bf16 v[212:215], v[100:103], v[48:51], v[212:215]
  v_add_f32_dpp v11, v223, v222 wave_shr:1 row_mask:0xf bank_mask:0xf
  v_add_f32_dpp v13, v10, v221 wave_ror:1 row_mask:0xf bank_mask:0xf
  v_mfma_f32_16x16x32_bf16 v[212:215], v[108:111], v[44:47], v[212:215]
  v_add_f32_dpp v13, v11, v221 wave_shr:1 row_mask:0xf bank_mask:0xf
  v_add_f32_dpp v14, v12, v220 wave_ror:1 row_mask:0xf bank_mask:0xf
  v_mfma_f32_16x16x32_bf16 v[212:215], v[116:119], v[40:43], v[212:215]
  v_add_f32_dpp v14, v13, v220 wave_shr:1 row_mask:0xf bank_mask:0xf
  s_waitcnt lgkmcnt(3)
  v_mfma_f32_16x16x32_bf16 v[212:215], v[124:127], v[36:39], v[212:215]
  v_fma_f32 v14, v16, s37, v14
  v_cvt_pk_bf16_f32 v220, v14, v14
  v_mfma_f32_16x16x32_bf16 v[212:215], v[132:135], v[32:35], v[212:215]
  buffer_store_short v220, v6, s[12:15], 0 offen offset:2176 sc1
  v_mfma_f32_16x16x32_bf16 v[212:215], v[140:143], v[28:31], v[212:215]
  v_mfma_f32_16x16x32_bf16 v[212:215], v[148:151], v[24:27], v[212:215]
  v_mfma_f32_16x16x32_bf16 v[212:215], v[156:159], v[20:23], v[212:215]
  s_waitcnt lgkmcnt(4)
  v_mfma_f32_16x16x32_bf16 v[216:219], v[88:91], v[56:59], 0
  ds_read_b64_tr_b16 v[168:169], v4 offset:2688
  ds_read_b64_tr_b16 v[170:171], v4 offset:2720
  v_mfma_f32_16x16x32_bf16 v[216:219], v[96:99], v[52:55], v[216:219]
  ds_read_u16_d16_hi v16, v5 offset:2432
  v_mfma_f32_16x16x32_bf16 v[216:219], v[104:107], v[48:51], v[216:219]
  v_mfma_f32_16x16x32_bf16 v[216:219], v[112:115], v[44:47], v[216:219]
  v_mfma_f32_16x16x32_bf16 v[216:219], v[120:123], v[40:43], v[216:219]
  v_add_f32_dpp v10, v223, v214 wave_ror:1 row_mask:0xf bank_mask:0xf
  v_add_f32_dpp v10, v215, v214 wave_shr:1 row_mask:0xf bank_mask:0xf
  v_mfma_f32_16x16x32_bf16 v[216:219], v[128:131], v[36:39], v[216:219]
  v_add_f32_dpp v12, v11, v213 wave_ror:1 row_mask:0xf bank_mask:0xf
  v_mfma_f32_16x16x32_bf16 v[216:219], v[136:139], v[32:35], v[216:219]
  v_add_f32_dpp v12, v10, v213 wave_shr:1 row_mask:0xf bank_mask:0xf
  v_add_f32_dpp v14, v13, v212 wave_ror:1 row_mask:0xf bank_mask:0xf
  v_mfma_f32_16x16x32_bf16 v[216:219], v[144:147], v[28:31], v[216:219]
  v_add_f32_dpp v14, v12, v212 wave_shr:1 row_mask:0xf bank_mask:0xf
  s_waitcnt lgkmcnt(3)
  v_mfma_f32_16x16x32_bf16 v[216:219], v[152:155], v[24:27], v[216:219]
  v_fma_f32 v14, v15, s37, v14
  v_cvt_pk_bf16_f32 v212, v14, v14
  v_mfma_f32_16x16x32_bf16 v[216:219], v[160:163], v[20:23], v[216:219]
  buffer_store_short v212, v6, s[12:15], 0 offen offset:2304 sc1
  s_waitcnt lgkmcnt(4)
  v_mfma_f32_16x16x32_bf16 v[220:223], v[84:87], v[60:63], 0
  ds_read_b64_tr_b16 v[172:173], v4 offset:2816
  ds_read_b64_tr_b16 v[174:175], v4 offset:2848
  v_mfma_f32_16x16x32_bf16 v[220:223], v[92:95], v[56:59], v[220:223]
  ds_read_u16_d16_hi v15, v5 offset:2560
  v_mfma_f32_16x16x32_bf16 v[220:223], v[100:103], v[52:55], v[220:223]
  v_mfma_f32_16x16x32_bf16 v[220:223], v[108:111], v[48:51], v[220:223]
  v_add_f32_dpp v11, v215, v218 wave_ror:1 row_mask:0xf bank_mask:0xf
  v_add_f32_dpp v11, v219, v218 wave_shr:1 row_mask:0xf bank_mask:0xf
  v_mfma_f32_16x16x32_bf16 v[220:223], v[116:119], v[44:47], v[220:223]
  v_add_f32_dpp v13, v10, v217 wave_ror:1 row_mask:0xf bank_mask:0xf
  v_mfma_f32_16x16x32_bf16 v[220:223], v[124:127], v[40:43], v[220:223]
  v_add_f32_dpp v13, v11, v217 wave_shr:1 row_mask:0xf bank_mask:0xf
  v_add_f32_dpp v14, v12, v216 wave_ror:1 row_mask:0xf bank_mask:0xf
  v_mfma_f32_16x16x32_bf16 v[220:223], v[132:135], v[36:39], v[220:223]
  v_add_f32_dpp v14, v13, v216 wave_shr:1 row_mask:0xf bank_mask:0xf
  s_waitcnt lgkmcnt(3)
  v_mfma_f32_16x16x32_bf16 v[220:223], v[140:143], v[32:35], v[220:223]
  v_fma_f32 v14, v16, s37, v14
  v_cvt_pk_bf16_f32 v216, v14, v14
  v_mfma_f32_16x16x32_bf16 v[220:223], v[148:151], v[28:31], v[220:223]
  buffer_store_short v216, v6, s[12:15], 0 offen offset:2432 sc1
  v_mfma_f32_16x16x32_bf16 v[220:223], v[156:159], v[24:27], v[220:223]
  v_mfma_f32_16x16x32_bf16 v[220:223], v[164:167], v[20:23], v[220:223]
  s_waitcnt lgkmcnt(4)
  v_mfma_f32_16x16x32_bf16 v[212:215], v[88:91], v[60:63], 0
  ds_read_b64_tr_b16 v[176:177], v4 offset:2944
  ds_read_b64_tr_b16 v[178:179], v4 offset:2976
  v_mfma_f32_16x16x32_bf16 v[212:215], v[96:99], v[56:59], v[212:215]
  ds_read_u16_d16_hi v16, v5 offset:2688
  v_mfma_f32_16x16x32_bf16 v[212:215], v[104:107], v[52:55], v[212:215]
  v_mfma_f32_16x16x32_bf16 v[212:215], v[112:115], v[48:51], v[212:215]
  v_mfma_f32_16x16x32_bf16 v[212:215], v[120:123], v[44:47], v[212:215]
  v_add_f32_dpp v10, v219, v222 wave_ror:1 row_mask:0xf bank_mask:0xf
  v_add_f32_dpp v10, v223, v222 wave_shr:1 row_mask:0xf bank_mask:0xf
  v_mfma_f32_16x16x32_bf16 v[212:215], v[128:131], v[40:43], v[212:215]
  v_add_f32_dpp v12, v11, v221 wave_ror:1 row_mask:0xf bank_mask:0xf
  v_mfma_f32_16x16x32_bf16 v[212:215], v[136:139], v[36:39], v[212:215]
  v_add_f32_dpp v12, v10, v221 wave_shr:1 row_mask:0xf bank_mask:0xf
  v_add_f32_dpp v14, v13, v220 wave_ror:1 row_mask:0xf bank_mask:0xf
  v_mfma_f32_16x16x32_bf16 v[212:215], v[144:147], v[32:35], v[212:215]
  v_add_f32_dpp v14, v12, v220 wave_shr:1 row_mask:0xf bank_mask:0xf
  s_waitcnt lgkmcnt(3)
  v_mfma_f32_16x16x32_bf16 v[212:215], v[152:155], v[28:31], v[212:215]
  v_fma_f32 v14, v15, s37, v14
  v_cvt_pk_bf16_f32 v220, v14, v14
  v_mfma_f32_16x16x32_bf16 v[212:215], v[160:163], v[24:27], v[212:215]
  buffer_store_short v220, v6, s[12:15], 0 offen offset:2560 sc1
  v_mfma_f32_16x16x32_bf16 v[212:215], v[168:171], v[20:23], v[212:215]
  s_waitcnt lgkmcnt(4)
  v_mfma_f32_16x16x32_bf16 v[216:219], v[84:87], v[64:67], 0
  ds_read_b64_tr_b16 v[180:181], v4 offset:3072
  ds_read_b64_tr_b16 v[182:183], v4 offset:3104
  v_mfma_f32_16x16x32_bf16 v[216:219], v[92:95], v[60:63], v[216:219]
  ds_read_u16_d16_hi v15, v5 offset:2816
  v_mfma_f32_16x16x32_bf16 v[216:219], v[100:103], v[56:59], v[216:219]
  v_mfma_f32_16x16x32_bf16 v[216:219], v[108:111], v[52:55], v[216:219]
  v_mfma_f32_16x16x32_bf16 v[216:219], v[116:119], v[48:51], v[216:219]
  v_add_f32_dpp v11, v223, v214 wave_ror:1 row_mask:0xf bank_mask:0xf
  v_add_f32_dpp v11, v215, v214 wave_shr:1 row_mask:0xf bank_mask:0xf
  v_mfma_f32_16x16x32_bf16 v[216:219], v[124:127], v[44:47], v[216:219]
  v_add_f32_dpp v13, v10, v213 wave_ror:1 row_mask:0xf bank_mask:0xf
  v_mfma_f32_16x16x32_bf16 v[216:219], v[132:135], v[40:43], v[216:219]
  v_add_f32_dpp v13, v11, v213 wave_shr:1 row_mask:0xf bank_mask:0xf
  v_add_f32_dpp v14, v12, v212 wave_ror:1 row_mask:0xf bank_mask:0xf
  v_mfma_f32_16x16x32_bf16 v[216:219], v[140:143], v[36:39], v[216:219]
  v_add_f32_dpp v14, v13, v212 wave_shr:1 row_mask:0xf bank_mask:0xf
  s_waitcnt lgkmcnt(3)
  v_mfma_f32_16x16x32_bf16 v[216:219], v[148:151], v[32:35], v[216:219]
  v_fma_f32 v14, v16, s37, v14
  v_cvt_pk_bf16_f32 v212, v14, v14
  v_mfma_f32_16x16x32_bf16 v[216:219], v[156:159], v[28:31], v[216:219]
  buffer_store_short v212, v6, s[12:15], 0 offen offset:2688 sc1
  v_mfma_f32_16x16x32_bf16 v[216:219], v[164:167], v[24:27], v[216:219]
  v_mfma_f32_16x16x32_bf16 v[216:219], v[172:175], v[20:23], v[216:219]
  s_waitcnt lgkmcnt(4)
  v_mfma_f32_16x16x32_bf16 v[220:223], v[88:91], v[64:67], 0
  ds_read_b64_tr_b16 v[184:185], v4 offset:3200
  ds_read_b64_tr_b16 v[186:187], v4 offset:3232
  v_mfma_f32_16x16x32_bf16 v[220:223], v[96:99], v[60:63], v[220:223]
  ds_read_u16_d16_hi v16, v5 offset:2944
  v_mfma_f32_16x16x32_bf16 v[220:223], v[104:107], v[56:59], v[220:223]
  v_mfma_f32_16x16x32_bf16 v[220:223], v[112:115], v[52:55], v[220:223]
  v_mfma_f32_16x16x32_bf16 v[220:223], v[120:123], v[48:51], v[220:223]
  v_add_f32_dpp v10, v215, v218 wave_ror:1 row_mask:0xf bank_mask:0xf
  v_add_f32_dpp v10, v219, v218 wave_shr:1 row_mask:0xf bank_mask:0xf
  v_mfma_f32_16x16x32_bf16 v[220:223], v[128:131], v[44:47], v[220:223]
  v_add_f32_dpp v12, v11, v217 wave_ror:1 row_mask:0xf bank_mask:0xf
  v_mfma_f32_16x16x32_bf16 v[220:223], v[136:139], v[40:43], v[220:223]
  v_add_f32_dpp v12, v10, v217 wave_shr:1 row_mask:0xf bank_mask:0xf
  v_add_f32_dpp v14, v13, v216 wave_ror:1 row_mask:0xf bank_mask:0xf
  v_mfma_f32_16x16x32_bf16 v[220:223], v[144:147], v[36:39], v[220:223]
  v_add_f32_dpp v14, v12, v216 wave_shr:1 row_mask:0xf bank_mask:0xf
  s_waitcnt lgkmcnt(3)
  v_mfma_f32_16x16x32_bf16 v[220:223], v[152:155], v[32:35], v[220:223]
  v_fma_f32 v14, v15, s37, v14
  v_cvt_pk_bf16_f32 v216, v14, v14
  v_mfma_f32_16x16x32_bf16 v[220:223], v[160:163], v[28:31], v[220:223]
  buffer_store_short v216, v6, s[12:15], 0 offen offset:2816 sc1
  v_mfma_f32_16x16x32_bf16 v[220:223], v[168:171], v[24:27], v[220:223]
  v_mfma_f32_16x16x32_bf16 v[220:223], v[176:179], v[20:23], v[220:223]
  s_waitcnt lgkmcnt(4)
  v_mfma_f32_16x16x32_bf16 v[212:215], v[84:87], v[68:71], 0
  ds_read_b64_tr_b16 v[188:189], v4 offset:3328
  ds_read_b64_tr_b16 v[190:191], v4 offset:3360
  v_mfma_f32_16x16x32_bf16 v[212:215], v[92:95], v[64:67], v[212:215]
  ds_read_u16_d16_hi v15, v5 offset:3072
  v_mfma_f32_16x16x32_bf16 v[212:215], v[100:103], v[60:63], v[212:215]
  v_mfma_f32_16x16x32_bf16 v[212:215], v[108:111], v[56:59], v[212:215]
  v_mfma_f32_16x16x32_bf16 v[212:215], v[116:119], v[52:55], v[212:215]
  v_add_f32_dpp v11, v219, v222 wave_ror:1 row_mask:0xf bank_mask:0xf
  v_add_f32_dpp v11, v223, v222 wave_shr:1 row_mask:0xf bank_mask:0xf
  v_mfma_f32_16x16x32_bf16 v[212:215], v[124:127], v[48:51], v[212:215]
  v_add_f32_dpp v13, v10, v221 wave_ror:1 row_mask:0xf bank_mask:0xf
  v_mfma_f32_16x16x32_bf16 v[212:215], v[132:135], v[44:47], v[212:215]
  v_add_f32_dpp v13, v11, v221 wave_shr:1 row_mask:0xf bank_mask:0xf
  v_add_f32_dpp v14, v12, v220 wave_ror:1 row_mask:0xf bank_mask:0xf
  v_mfma_f32_16x16x32_bf16 v[212:215], v[140:143], v[40:43], v[212:215]
  v_add_f32_dpp v14, v13, v220 wave_shr:1 row_mask:0xf bank_mask:0xf
  s_waitcnt lgkmcnt(3)
  v_mfma_f32_16x16x32_bf16 v[212:215], v[148:151], v[36:39], v[212:215]
  v_fma_f32 v14, v16, s37, v14
  v_cvt_pk_bf16_f32 v220, v14, v14
  v_mfma_f32_16x16x32_bf16 v[212:215], v[156:159], v[32:35], v[212:215]
  buffer_store_short v220, v6, s[12:15], 0 offen offset:2944 sc1
  v_mfma_f32_16x16x32_bf16 v[212:215], v[164:167], v[28:31], v[212:215]
  v_mfma_f32_16x16x32_bf16 v[212:215], v[172:175], v[24:27], v[212:215]
  v_mfma_f32_16x16x32_bf16 v[212:215], v[180:183], v[20:23], v[212:215]
  s_waitcnt lgkmcnt(4)
  v_mfma_f32_16x16x32_bf16 v[216:219], v[88:91], v[68:71], 0
  ds_read_b64_tr_b16 v[192:193], v4 offset:3456
  ds_read_b64_tr_b16 v[194:195], v4 offset:3488
  v_mfma_f32_16x16x32_bf16 v[216:219], v[96:99], v[64:67], v[216:219]
  ds_read_u16_d16_hi v16, v5 offset:3200
  v_mfma_f32_16x16x32_bf16 v[216:219], v[104:107], v[60:63], v[216:219]
  v_mfma_f32_16x16x32_bf16 v[216:219], v[112:115], v[56:59], v[216:219]
  v_mfma_f32_16x16x32_bf16 v[216:219], v[120:123], v[52:55], v[216:219]
  v_add_f32_dpp v10, v223, v214 wave_ror:1 row_mask:0xf bank_mask:0xf
  v_add_f32_dpp v10, v215, v214 wave_shr:1 row_mask:0xf bank_mask:0xf
  v_mfma_f32_16x16x32_bf16 v[216:219], v[128:131], v[48:51], v[216:219]
  v_add_f32_dpp v12, v11, v213 wave_ror:1 row_mask:0xf bank_mask:0xf
  v_mfma_f32_16x16x32_bf16 v[216:219], v[136:139], v[44:47], v[216:219]
  v_add_f32_dpp v12, v10, v213 wave_shr:1 row_mask:0xf bank_mask:0xf
  v_add_f32_dpp v14, v13, v212 wave_ror:1 row_mask:0xf bank_mask:0xf
  v_mfma_f32_16x16x32_bf16 v[216:219], v[144:147], v[40:43], v[216:219]
  v_add_f32_dpp v14, v12, v212 wave_shr:1 row_mask:0xf bank_mask:0xf
  s_waitcnt lgkmcnt(3)
  v_mfma_f32_16x16x32_bf16 v[216:219], v[152:155], v[36:39], v[216:219]
  v_fma_f32 v14, v15, s37, v14
  v_cvt_pk_bf16_f32 v212, v14, v14
  v_mfma_f32_16x16x32_bf16 v[216:219], v[160:163], v[32:35], v[216:219]
  buffer_store_short v212, v6, s[12:15], 0 offen offset:3072 sc1
  v_mfma_f32_16x16x32_bf16 v[216:219], v[168:171], v[28:31], v[216:219]
  v_mfma_f32_16x16x32_bf16 v[216:219], v[176:179], v[24:27], v[216:219]
  v_mfma_f32_16x16x32_bf16 v[216:219], v[184:187], v[20:23], v[216:219]
  s_waitcnt lgkmcnt(4)
  v_mfma_f32_16x16x32_bf16 v[220:223], v[84:87], v[72:75], 0
  ds_read_b64_tr_b16 v[196:197], v4 offset:3584
  ds_read_b64_tr_b16 v[198:199], v4 offset:3616
  v_mfma_f32_16x16x32_bf16 v[220:223], v[92:95], v[68:71], v[220:223]
  ds_read_u16_d16_hi v15, v5 offset:3328
  v_mfma_f32_16x16x32_bf16 v[220:223], v[100:103], v[64:67], v[220:223]
  v_mfma_f32_16x16x32_bf16 v[220:223], v[108:111], v[60:63], v[220:223]
  v_mfma_f32_16x16x32_bf16 v[220:223], v[116:119], v[56:59], v[220:223]
  v_add_f32_dpp v11, v215, v218 wave_ror:1 row_mask:0xf bank_mask:0xf
  v_add_f32_dpp v11, v219, v218 wave_shr:1 row_mask:0xf bank_mask:0xf
  v_mfma_f32_16x16x32_bf16 v[220:223], v[124:127], v[52:55], v[220:223]
  v_add_f32_dpp v13, v10, v217 wave_ror:1 row_mask:0xf bank_mask:0xf
  v_mfma_f32_16x16x32_bf16 v[220:223], v[132:135], v[48:51], v[220:223]
  v_add_f32_dpp v13, v11, v217 wave_shr:1 row_mask:0xf bank_mask:0xf
  v_add_f32_dpp v14, v12, v216 wave_ror:1 row_mask:0xf bank_mask:0xf
  v_mfma_f32_16x16x32_bf16 v[220:223], v[140:143], v[44:47], v[220:223]
  v_add_f32_dpp v14, v13, v216 wave_shr:1 row_mask:0xf bank_mask:0xf
  s_waitcnt lgkmcnt(3)
  v_mfma_f32_16x16x32_bf16 v[220:223], v[148:151], v[40:43], v[220:223]
  v_fma_f32 v14, v16, s37, v14
  v_cvt_pk_bf16_f32 v216, v14, v14
  v_mfma_f32_16x16x32_bf16 v[220:223], v[156:159], v[36:39], v[220:223]
  buffer_store_short v216, v6, s[12:15], 0 offen offset:3200 sc1
  v_mfma_f32_16x16x32_bf16 v[220:223], v[164:167], v[32:35], v[220:223]
  v_mfma_f32_16x16x32_bf16 v[220:223], v[172:175], v[28:31], v[220:223]
  v_mfma_f32_16x16x32_bf16 v[220:223], v[180:183], v[24:27], v[220:223]
  v_mfma_f32_16x16x32_bf16 v[220:223], v[188:191], v[20:23], v[220:223]
  s_waitcnt lgkmcnt(4)
  v_mfma_f32_16x16x32_bf16 v[212:215], v[88:91], v[72:75], 0
  ds_read_b64_tr_b16 v[200:201], v4 offset:3712
  ds_read_b64_tr_b16 v[202:203], v4 offset:3744
  v_mfma_f32_16x16x32_bf16 v[212:215], v[96:99], v[68:71], v[212:215]
  ds_read_u16_d16_hi v16, v5 offset:3456
  v_mfma_f32_16x16x32_bf16 v[212:215], v[104:107], v[64:67], v[212:215]
  v_mfma_f32_16x16x32_bf16 v[212:215], v[112:115], v[60:63], v[212:215]
  v_mfma_f32_16x16x32_bf16 v[212:215], v[120:123], v[56:59], v[212:215]
  v_add_f32_dpp v10, v219, v222 wave_ror:1 row_mask:0xf bank_mask:0xf
  v_add_f32_dpp v10, v223, v222 wave_shr:1 row_mask:0xf bank_mask:0xf
  v_mfma_f32_16x16x32_bf16 v[212:215], v[128:131], v[52:55], v[212:215]
  v_add_f32_dpp v12, v11, v221 wave_ror:1 row_mask:0xf bank_mask:0xf
  v_mfma_f32_16x16x32_bf16 v[212:215], v[136:139], v[48:51], v[212:215]
  v_add_f32_dpp v12, v10, v221 wave_shr:1 row_mask:0xf bank_mask:0xf
  v_add_f32_dpp v14, v13, v220 wave_ror:1 row_mask:0xf bank_mask:0xf
  v_mfma_f32_16x16x32_bf16 v[212:215], v[144:147], v[44:47], v[212:215]
  v_add_f32_dpp v14, v12, v220 wave_shr:1 row_mask:0xf bank_mask:0xf
  s_waitcnt lgkmcnt(3)
  v_mfma_f32_16x16x32_bf16 v[212:215], v[152:155], v[40:43], v[212:215]
  v_fma_f32 v14, v15, s37, v14
  v_cvt_pk_bf16_f32 v220, v14, v14
  v_mfma_f32_16x16x32_bf16 v[212:215], v[160:163], v[36:39], v[212:215]
  buffer_store_short v220, v6, s[12:15], 0 offen offset:3328 sc1
  v_mfma_f32_16x16x32_bf16 v[212:215], v[168:171], v[32:35], v[212:215]
  v_mfma_f32_16x16x32_bf16 v[212:215], v[176:179], v[28:31], v[212:215]
  v_mfma_f32_16x16x32_bf16 v[212:215], v[184:187], v[24:27], v[212:215]
  v_mfma_f32_16x16x32_bf16 v[212:215], v[192:195], v[20:23], v[212:215]
  s_waitcnt lgkmcnt(4)
  v_mfma_f32_16x16x32_bf16 v[216:219], v[84:87], v[76:79], 0
  ds_read_b64_tr_b16 v[204:205], v4 offset:3840
  ds_read_b64_tr_b16 v[206:207], v4 offset:3872
  v_mfma_f32_16x16x32_bf16 v[216:219], v[92:95], v[72:75], v[216:219]
  ds_read_u16_d16_hi v15, v5 offset:3584
  v_mfma_f32_16x16x32_bf16 v[216:219], v[100:103], v[68:71], v[216:219]
  v_mfma_f32_16x16x32_bf16 v[216:219], v[108:111], v[64:67], v[216:219]
  v_mfma_f32_16x16x32_bf16 v[216:219], v[116:119], v[60:63], v[216:219]
  v_add_f32_dpp v11, v223, v214 wave_ror:1 row_mask:0xf bank_mask:0xf
  v_add_f32_dpp v11, v215, v214 wave_shr:1 row_mask:0xf bank_mask:0xf
  v_mfma_f32_16x16x32_bf16 v[216:219], v[124:127], v[56:59], v[216:219]
  v_add_f32_dpp v13, v10, v213 wave_ror:1 row_mask:0xf bank_mask:0xf
  v_mfma_f32_16x16x32_bf16 v[216:219], v[132:135], v[52:55], v[216:219]
  v_add_f32_dpp v13, v11, v213 wave_shr:1 row_mask:0xf bank_mask:0xf
  v_add_f32_dpp v14, v12, v212 wave_ror:1 row_mask:0xf bank_mask:0xf
  v_mfma_f32_16x16x32_bf16 v[216:219], v[140:143], v[48:51], v[216:219]
  v_add_f32_dpp v14, v13, v212 wave_shr:1 row_mask:0xf bank_mask:0xf
  s_waitcnt lgkmcnt(3)
  v_mfma_f32_16x16x32_bf16 v[216:219], v[148:151], v[44:47], v[216:219]
  v_fma_f32 v14, v16, s37, v14
  v_cvt_pk_bf16_f32 v212, v14, v14
  v_mfma_f32_16x16x32_bf16 v[216:219], v[156:159], v[40:43], v[216:219]
  buffer_store_short v212, v6, s[12:15], 0 offen offset:3456 sc1
  v_mfma_f32_16x16x32_bf16 v[216:219], v[164:167], v[36:39], v[216:219]
  v_mfma_f32_16x16x32_bf16 v[216:219], v[172:175], v[32:35], v[216:219]
  v_mfma_f32_16x16x32_bf16 v[216:219], v[180:183], v[28:31], v[216:219]
  v_mfma_f32_16x16x32_bf16 v[216:219], v[188:191], v[24:27], v[216:219]
  v_mfma_f32_16x16x32_bf16 v[216:219], v[196:199], v[20:23], v[216:219]
  s_waitcnt lgkmcnt(4)
  v_mfma_f32_16x16x32_bf16 v[220:223], v[88:91], v[76:79], 0
  ds_read_b64_tr_b16 v[208:209], v4 offset:3968
  ds_read_b64_tr_b16 v[210:211], v4 offset:4000
  v_mfma_f32_16x16x32_bf16 v[220:223], v[96:99], v[72:75], v[220:223]
  ds_read_u16_d16_hi v16, v5 offset:3712
  v_mfma_f32_16x16x32_bf16 v[220:223], v[104:107], v[68:71], v[220:223]
  v_mfma_f32_16x16x32_bf16 v[220:223], v[112:115], v[64:67], v[220:223]
  v_mfma_f32_16x16x32_bf16 v[220:223], v[120:123], v[60:63], v[220:223]
  v_add_f32_dpp v10, v215, v218 wave_ror:1 row_mask:0xf bank_mask:0xf
  v_add_f32_dpp v10, v219, v218 wave_shr:1 row_mask:0xf bank_mask:0xf
  v_mfma_f32_16x16x32_bf16 v[220:223], v[128:131], v[56:59], v[220:223]
  v_add_f32_dpp v12, v11, v217 wave_ror:1 row_mask:0xf bank_mask:0xf
  v_mfma_f32_16x16x32_bf16 v[220:223], v[136:139], v[52:55], v[220:223]
  v_add_f32_dpp v12, v10, v217 wave_shr:1 row_mask:0xf bank_mask:0xf
  v_add_f32_dpp v14, v13, v216 wave_ror:1 row_mask:0xf bank_mask:0xf
  v_mfma_f32_16x16x32_bf16 v[220:223], v[144:147], v[48:51], v[220:223]
  v_add_f32_dpp v14, v12, v216 wave_shr:1 row_mask:0xf bank_mask:0xf
  s_waitcnt lgkmcnt(3)
  v_mfma_f32_16x16x32_bf16 v[220:223], v[152:155], v[44:47], v[220:223]
  v_fma_f32 v14, v15, s37, v14
  v_cvt_pk_bf16_f32 v216, v14, v14
  v_mfma_f32_16x16x32_bf16 v[220:223], v[160:163], v[40:43], v[220:223]
  buffer_store_short v216, v6, s[12:15], 0 offen offset:3584 sc1
  v_mfma_f32_16x16x32_bf16 v[220:223], v[168:171], v[36:39], v[220:223]
  v_mfma_f32_16x16x32_bf16 v[220:223], v[176:179], v[32:35], v[220:223]
  v_mfma_f32_16x16x32_bf16 v[220:223], v[184:187], v[28:31], v[220:223]
  v_mfma_f32_16x16x32_bf16 v[220:223], v[192:195], v[24:27], v[220:223]
  v_mfma_f32_16x16x32_bf16 v[220:223], v[200:203], v[20:23], v[220:223]
  s_waitcnt lgkmcnt(4)
  v_mfma_f32_16x16x32_bf16 v[212:215], v[84:87], v[80:83], 0
  ds_read_u16_d16_hi v15, v5 offset:3840
  v_mfma_f32_16x16x32_bf16 v[212:215], v[92:95], v[76:79], v[212:215]
  v_mfma_f32_16x16x32_bf16 v[212:215], v[100:103], v[72:75], v[212:215]
  v_mfma_f32_16x16x32_bf16 v[212:215], v[108:111], v[68:71], v[212:215]
  v_mfma_f32_16x16x32_bf16 v[212:215], v[116:119], v[64:67], v[212:215]
  v_mfma_f32_16x16x32_bf16 v[212:215], v[124:127], v[60:63], v[212:215]
  v_mfma_f32_16x16x32_bf16 v[212:215], v[132:135], v[56:59], v[212:215]
  v_add_f32_dpp v11, v219, v222 wave_ror:1 row_mask:0xf bank_mask:0xf
  v_add_f32_dpp v11, v223, v222 wave_shr:1 row_mask:0xf bank_mask:0xf
  v_mfma_f32_16x16x32_bf16 v[212:215], v[140:143], v[52:55], v[212:215]
  v_add_f32_dpp v13, v10, v221 wave_ror:1 row_mask:0xf bank_mask:0xf
  v_mfma_f32_16x16x32_bf16 v[212:215], v[148:151], v[48:51], v[212:215]
  v_add_f32_dpp v13, v11, v221 wave_shr:1 row_mask:0xf bank_mask:0xf
  v_add_f32_dpp v14, v12, v220 wave_ror:1 row_mask:0xf bank_mask:0xf
  v_mfma_f32_16x16x32_bf16 v[212:215], v[156:159], v[44:47], v[212:215]
  v_add_f32_dpp v14, v13, v220 wave_shr:1 row_mask:0xf bank_mask:0xf
  s_waitcnt lgkmcnt(1)
  v_mfma_f32_16x16x32_bf16 v[212:215], v[164:167], v[40:43], v[212:215]
  v_fma_f32 v14, v16, s37, v14
  v_cvt_pk_bf16_f32 v220, v14, v14
  v_mfma_f32_16x16x32_bf16 v[212:215], v[172:175], v[36:39], v[212:215]
  buffer_store_short v220, v6, s[12:15], 0 offen offset:3712 sc1
  v_mfma_f32_16x16x32_bf16 v[212:215], v[180:183], v[32:35], v[212:215]
  v_mfma_f32_16x16x32_bf16 v[212:215], v[188:191], v[28:31], v[212:215]
  v_mfma_f32_16x16x32_bf16 v[212:215], v[196:199], v[24:27], v[212:215]
  v_mfma_f32_16x16x32_bf16 v[212:215], v[204:207], v[20:23], v[212:215]
  s_waitcnt lgkmcnt(2)
  v_mfma_f32_16x16x32_bf16 v[216:219], v[88:91], v[80:83], 0
  ds_read_u16_d16_hi v16, v5 offset:3968
  v_mfma_f32_16x16x32_bf16 v[216:219], v[96:99], v[76:79], v[216:219]
  v_mfma_f32_16x16x32_bf16 v[216:219], v[104:107], v[72:75], v[216:219]
  v_mfma_f32_16x16x32_bf16 v[216:219], v[112:115], v[68:71], v[216:219]
  v_mfma_f32_16x16x32_bf16 v[216:219], v[120:123], v[64:67], v[216:219]
  v_mfma_f32_16x16x32_bf16 v[216:219], v[128:131], v[60:63], v[216:219]
  v_mfma_f32_16x16x32_bf16 v[216:219], v[136:139], v[56:59], v[216:219]
  v_add_f32_dpp v10, v223, v214 wave_ror:1 row_mask:0xf bank_mask:0xf
  v_add_f32_dpp v10, v215, v214 wave_shr:1 row_mask:0xf bank_mask:0xf
  v_mfma_f32_16x16x32_bf16 v[216:219], v[144:147], v[52:55], v[216:219]
  v_add_f32_dpp v12, v11, v213 wave_ror:1 row_mask:0xf bank_mask:0xf
  v_mfma_f32_16x16x32_bf16 v[216:219], v[152:155], v[48:51], v[216:219]
  v_add_f32_dpp v12, v10, v213 wave_shr:1 row_mask:0xf bank_mask:0xf
  v_add_f32_dpp v14, v13, v212 wave_ror:1 row_mask:0xf bank_mask:0xf
  v_mfma_f32_16x16x32_bf16 v[216:219], v[160:163], v[44:47], v[216:219]
  v_add_f32_dpp v14, v12, v212 wave_shr:1 row_mask:0xf bank_mask:0xf
  s_waitcnt lgkmcnt(1)
  v_mfma_f32_16x16x32_bf16 v[216:219], v[168:171], v[40:43], v[216:219]
  v_fma_f32 v14, v15, s37, v14
  v_cvt_pk_bf16_f32 v212, v14, v14
  v_mfma_f32_16x16x32_bf16 v[216:219], v[176:179], v[36:39], v[216:219]
  buffer_store_short v212, v6, s[12:15], 0 offen offset:3840 sc1
  v_mfma_f32_16x16x32_bf16 v[216:219], v[184:187], v[32:35], v[216:219]
  v_mfma_f32_16x16x32_bf16 v[216:219], v[192:195], v[28:31], v[216:219]
  v_mfma_f32_16x16x32_bf16 v[216:219], v[200:203], v[24:27], v[216:219]
  v_mfma_f32_16x16x32_bf16 v[216:219], v[208:211], v[20:23], v[216:219]
  s_nop 7
  v_add_f32_dpp v11, v215, v218 wave_ror:1 row_mask:0xf bank_mask:0xf
  v_add_f32_dpp v11, v219, v218 wave_shr:1 row_mask:0xf bank_mask:0xf
  v_add_f32_dpp v13, v10, v217 wave_ror:1 row_mask:0xf bank_mask:0xf
  s_nop 0
  v_add_f32_dpp v13, v11, v217 wave_shr:1 row_mask:0xf bank_mask:0xf
  v_add_f32_dpp v14, v12, v216 wave_ror:1 row_mask:0xf bank_mask:0xf
  s_nop 0
  v_add_f32_dpp v14, v13, v216 wave_shr:1 row_mask:0xf bank_mask:0xf
  s_waitcnt lgkmcnt(0)
  v_fma_f32 v14, v16, s37, v14
  v_cvt_pk_bf16_f32 v216, v14, v14
  buffer_store_short v216, v6, s[12:15], 0 offen offset:3968 sc1
cv_end:
  s_waitcnt vmcnt(0)
  s_add_u32 s22, s50, 4096
  v_mov_b32 v2, s22
  v_mov_b32 v3, s36
  s_mov_b64 exec, 1
  global_store_dword v2, v3, s[38:39] sc1
  s_mov_b64 exec, -1
  s_cmp_eq_u32 s33, 7
  s_cbranch_scc0 L_a_w2
  s_add_u32 s61, s63, 4096
  v_min_u32 v32, 63, v1
  v_lshlrev_b32 v32, 2, v32
  v_add_u32 v32, s61, v32
pz_pl40:
  global_load_dword v33, v32, s[38:39] sc1
  s_waitcnt vmcnt(0)
  v_cmp_ne_u32 vcc, s36, v33
  s_nop 1
  s_cbranch_vccz pz_pl40d
  s_sleep 2
  s_sub_u32 s99, s99, 1
  s_cbranch_scc0 pz_pl40
  s_branch L_exit
pz_pl40d:
L_a_w2:
  s_barrier
  s_load_dwordx2 s[42:43], s[0:1], 72
  s_add_u32 s8, s48, 0x600000
  s_addc_u32 s9, s49, 0
  s_and_b32 s9, s9, 0xffff
  s_mov_b32 s10, 2621440
  s_mov_b32 s11, 0x20000
  v_lshrrev_b32 v2, 3, v1
  v_and_b32 v3, 7, v1
  v_and_b32 v4, 2, v2
  s_and_b32 s22, s34, 1
  s_lshl_b32 s22, s22, 2
  v_or_b32 v4, s22, v4
  v_xor_b32 v3, v3, v4
  s_lshl_b32 s22, s26, 6
  s_lshl_b32 s23, s34, 4
  s_add_u32 s22, s22, s23
  v_add_u32 v2, s22, v2
  v_lshlrev_b32 v2, 12, v2
  v_lshl_add_u32 v2, v3, 4, v2
  s_lshl_b32 s23, s28, 1
  s_add_u32 m0, s31, 4128
  s_add_u32 s22, s23, 0
  buffer_load_dwordx4 v2, s[8:11], s22 offen sc1 lds
  s_add_u32 m0, s31, 5152
  s_add_u32 s22, s23, 32768
  buffer_load_dwordx4 v2, s[8:11], s22 offen sc1 lds
  s_add_u32 m0, s31, 6176
  s_add_u32 s22, s23, 128
  buffer_load_dwordx4 v2, s[8:11], s22 offen sc1 lds
  s_add_u32 m0, s31, 7200
  s_add_u32 s22, s23, 32896
  buffer_load_dwordx4 v2, s[8:11], s22 offen sc1 lds
  s_waitcnt lgkmcnt(0)
  s_mov_b32 s12, s42
  s_and_b32 s13, s43, 0xffff
  s_mov_b32 s14, 5242880
  s_mov_b32 s15, 0x20000
  s_waitcnt vmcnt(0)
  s_barrier
  v_bfe_u32 v2, v1, 2, 2
  v_and_b32 v3, 3, v1
  v_lshrrev_b32 v4, 4, v1
  v_lshrrev_b32 v5, 1, v2
  v_and_b32 v6, 1, v4
  v_lshl_or_b32 v5, v6, 1, v5
  v_xor_b32 v5, s34, v5
  v_lshlrev_b32 v5, 5, v5
  v_lshl_add_u32 v5, v3, 3, v5
  v_lshl_add_u32 v5, v2, 7, v5
  v_mul_u32_u24 v6, 8448, v4
  s_mul_i32 s22, s35, 33792
  s_add_u32 s22, s22, 86048
  v_add3_u32 v8, v5, v6, s22
  v_and_b32 v2, 15, v1
  v_and_b32 v3, 7, v2
  v_lshlrev_b32 v6, 1, v4
  v_xor_b32 v6, v6, v3
  v_lshlrev_b32 v6, 4, v6
  v_lshl_add_u32 v6, v2, 7, v6
  v_add_u32 v9, s31, v6
  v_xor_b32 v10, 16, v9
  v_lshlrev_b32 v11, 4, v1
  v_add_u32 v11, s31, v11
  v_lshrrev_b32 v2, 3, v1
  v_and_b32 v3, 7, v1
  v_xor_b32 v3, v3, v2
  s_lshl_b32 s22, s34, 4
  s_add_u32 s22, s22, s28
  v_add_u32 v2, s22, v2
  v_mul_u32_u24 v2, 2560, v2
  v_lshl_add_u32 v32, v3, 4, v2
  s_lshl_b32 s23, s26, 7
  ds_read_b64_tr_b16 v[12:13], v8 offset:0
  ds_read_b64_tr_b16 v[14:15], v8 offset:512
  ds_read_b64_tr_b16 v[16:17], v8 offset:1024
  ds_read_b64_tr_b16 v[18:19], v8 offset:1536
  ds_read_b128 v[20:23], v9 offset:0
  ds_read_b128 v[24:27], v10 offset:0
  ds_read_b64_tr_b16 v[36:37], v8 offset:2048
  ds_read_b64_tr_b16 v[38:39], v8 offset:2560
  ds_read_b64_tr_b16 v[40:41], v8 offset:3072
  ds_read_b64_tr_b16 v[42:43], v8 offset:3584
  ds_read_b128 v[44:47], v9 offset:2048
  ds_read_b128 v[48:51], v10 offset:2048
  s_waitcnt lgkmcnt(6)
  v_lshlrev_b32 v28, 16, v12
  v_lshlrev_b32 v29, 16, v20
  v_and_b32 v30, 0xffff0000, v12
  v_and_b32 v31, 0xffff0000, v20
  v_mul_f32 v28, v28, v29
  v_mul_f32 v30, v30, v31
  v_cvt_pk_bf16_f32 v20, v28, v30
  v_lshlrev_b32 v28, 16, v13
  v_lshlrev_b32 v29, 16, v21
  v_and_b32 v30, 0xffff0000, v13
  v_and_b32 v31, 0xffff0000, v21
  v_mul_f32 v28, v28, v29
  v_mul_f32 v30, v30, v31
  v_cvt_pk_bf16_f32 v21, v28, v30
  v_lshlrev_b32 v28, 16, v14
  v_lshlrev_b32 v29, 16, v22
  v_and_b32 v30, 0xffff0000, v14
  v_and_b32 v31, 0xffff0000, v22
  v_mul_f32 v28, v28, v29
  v_mul_f32 v30, v30, v31
  v_cvt_pk_bf16_f32 v22, v28, v30
  v_lshlrev_b32 v28, 16, v15
  v_lshlrev_b32 v29, 16, v23
  v_and_b32 v30, 0xffff0000, v15
  v_and_b32 v31, 0xffff0000, v23
  v_mul_f32 v28, v28, v29
  v_mul_f32 v30, v30, v31
  v_cvt_pk_bf16_f32 v23, v28, v30
  v_lshlrev_b32 v28, 16, v16
  v_lshlrev_b32 v29, 16, v24
  v_and_b32 v30, 0xffff0000, v16
  v_and_b32 v31, 0xffff0000, v24
  v_mul_f32 v28, v28, v29
  v_mul_f32 v30, v30, v31
  v_cvt_pk_bf16_f32 v24, v28, v30
  v_lshlrev_b32 v28, 16, v17
  v_lshlrev_b32 v29, 16, v25
  v_and_b32 v30, 0xffff0000, v17
  v_and_b32 v31, 0xffff0000, v25
  v_mul_f32 v28, v28, v29
  v_mul_f32 v30, v30, v31
  v_cvt_pk_bf16_f32 v25, v28, v30
  v_lshlrev_b32 v28, 16, v18
  v_lshlrev_b32 v29, 16, v26
  v_and_b32 v30, 0xffff0000, v18
  v_and_b32 v31, 0xffff0000, v26
  v_mul_f32 v28, v28, v29
  v_mul_f32 v30, v30, v31
  v_cvt_pk_bf16_f32 v26, v28, v30
  v_lshlrev_b32 v28, 16, v19
  v_lshlrev_b32 v29, 16, v27
  v_and_b32 v30, 0xffff0000, v19
  v_and_b32 v31, 0xffff0000, v27
  v_mul_f32 v28, v28, v29
  v_mul_f32 v30, v30, v31
  v_cvt_pk_bf16_f32 v27, v28, v30
  ds_write_b128 v9, v[20:23] offset:0
  ds_write_b128 v10, v[24:27] offset:0
  s_waitcnt lgkmcnt(2)
  v_lshlrev_b32 v28, 16, v36
  v_lshlrev_b32 v29, 16, v44
  v_and_b32 v30, 0xffff0000, v36
  v_and_b32 v31, 0xffff0000, v44
  v_mul_f32 v28, v28, v29
  v_mul_f32 v30, v30, v31
  v_cvt_pk_bf16_f32 v44, v28, v30
  v_lshlrev_b32 v28, 16, v37
  v_lshlrev_b32 v29, 16, v45
  v_and_b32 v30, 0xffff0000, v37
  v_and_b32 v31, 0xffff0000, v45
  v_mul_f32 v28, v28, v29
  v_mul_f32 v30, v30, v31
  v_cvt_pk_bf16_f32 v45, v28, v30
  v_lshlrev_b32 v28, 16, v38
  v_lshlrev_b32 v29, 16, v46
  v_and_b32 v30, 0xffff0000, v38
  v_and_b32 v31, 0xffff0000, v46
  v_mul_f32 v28, v28, v29
  v_mul_f32 v30, v30, v31
  v_cvt_pk_bf16_f32 v46, v28, v30
  v_lshlrev_b32 v28, 16, v39
  v_lshlrev_b32 v29, 16, v47
  v_and_b32 v30, 0xffff0000, v39
  v_and_b32 v31, 0xffff0000, v47
  v_mul_f32 v28, v28, v29
  v_mul_f32 v30, v30, v31
  v_cvt_pk_bf16_f32 v47, v28, v30
  v_lshlrev_b32 v28, 16, v40
  v_lshlrev_b32 v29, 16, v48
  v_and_b32 v30, 0xffff0000, v40
  v_and_b32 v31, 0xffff0000, v48
  v_mul_f32 v28, v28, v29
  v_mul_f32 v30, v30, v31
  v_cvt_pk_bf16_f32 v48, v28, v30
  v_lshlrev_b32 v28, 16, v41
  v_lshlrev_b32 v29, 16, v49
  v_and_b32 v30, 0xffff0000, v41
  v_and_b32 v31, 0xffff0000, v49
  v_mul_f32 v28, v28, v29
  v_mul_f32 v30, v30, v31
  v_cvt_pk_bf16_f32 v49, v28, v30
  v_lshlrev_b32 v28, 16, v42
  v_lshlrev_b32 v29, 16, v50
  v_and_b32 v30, 0xffff0000, v42
  v_and_b32 v31, 0xffff0000, v50
  v_mul_f32 v28, v28, v29
  v_mul_f32 v30, v30, v31
  v_cvt_pk_bf16_f32 v50, v28, v30
  v_lshlrev_b32 v28, 16, v43
  v_lshlrev_b32 v29, 16, v51
  v_and_b32 v30, 0xffff0000, v43
  v_and_b32 v31, 0xffff0000, v51
  v_mul_f32 v28, v28, v29
  v_mul_f32 v30, v30, v31
  v_cvt_pk_bf16_f32 v51, v28, v30
  ds_write_b128 v9, v[44:47] offset:2048
  ds_write_b128 v10, v[48:51] offset:2048
  s_waitcnt lgkmcnt(0)
  ds_read_b128 v[12:15], v11 offset:0
  ds_read_b128 v[16:19], v11 offset:1024
  ds_read_b128 v[36:39], v11 offset:2048
  ds_read_b128 v[40:43], v11 offset:3072
  s_add_u32 s22, s23, 0
  s_waitcnt lgkmcnt(3)
  buffer_store_dwordx4 v[12:15], v32, s[12:15], s22 offen sc1 nt
  s_add_u32 s22, s23, 20480
  s_waitcnt lgkmcnt(2)
  buffer_store_dwordx4 v[16:19], v32, s[12:15], s22 offen sc1 nt
  s_add_u32 s22, s23, 163840
  s_waitcnt lgkmcnt(1)
  buffer_store_dwordx4 v[36:39], v32, s[12:15], s22 offen sc1 nt
  s_add_u32 s22, s23, 184320
  s_waitcnt lgkmcnt(0)
  buffer_store_dwordx4 v[40:43], v32, s[12:15], s22 offen sc1 nt
L_exit:
  s_endpgm
L_code_end:
.section .rodata,"a"
.p2align 6
.amdhsa_kernel mega_kernel
  .amdhsa_next_free_vgpr 256
  .amdhsa_next_free_sgpr 102
  .amdhsa_accum_offset 256
  .amdhsa_group_segment_fixed_size 0
  .amdhsa_kernarg_size 96
  .amdhsa_user_sgpr_count 2
  .amdhsa_user_sgpr_kernarg_segment_ptr 1
  .amdhsa_system_sgpr_workgroup_id_x 1
  .amdhsa_float_denorm_mode_32 3
  .amdhsa_float_denorm_mode_16_64 3
.end_amdhsa_kernel
```
